```python
import torch

def _softmax(x, axis=-1):
    return torch.softmax(x, dim=axis)

def _gelu(x):
    return torch.nn.functional.gelu(x, approximate='tanh')

def _silu(x):
    return torch.nn.functional.silu(x)

def _sigmoid(x):
    return torch.sigmoid(x)

def _layernorm(x, axis=-1, eps=1e-05):
    m = x.mean(dim=axis, keepdim=True)
    v = x.var(dim=axis, keepdim=True, unbiased=False)
    return (x - m) / torch.sqrt(v + eps)

def _scatter_add(tgt, idx, src, axis=0):
    return tgt.clone().index_add_(axis, idx, src)

def _segment_sum(src, seg, n):
    out = torch.zeros((n,) + src.shape[1:], dtype=src.dtype)
    return out.index_add_(0, seg, src)

def _pad(x, pw):
    flat = tuple((v for pair in reversed(pw) for v in pair))
    return torch.nn.functional.pad(x, flat)
kernel_name = 'standalone__conformer_conv_module__speech'

def setup_inputs():

    _w = lambda a: (lambda t: t.to(torch.bfloat16) if t.is_floating_point() else t)(torch.as_tensor(a))
    B, T, D, K = (2, 16000, 256, 3)
    return {'x': _w((lambda *s: torch.randn(*s, dtype=torch.bfloat16) * 0.2)(B, T, D)), 'w_pw1': _w((lambda *s: torch.randn(*s, dtype=torch.bfloat16) * 0.2)(D, 2 * D)), 'dw': _w((lambda *s: torch.randn(*s, dtype=torch.bfloat16) * 0.2)(K, D)), 'w_pw2': _w((lambda *s: torch.randn(*s, dtype=torch.bfloat16) * 0.05)(D, D))}

def reference(x, w_pw1, dw, w_pw2):
    B, T, D = x.shape
    K = dw.shape[0]
    h = x @ w_pw1
    a, b = (h[..., :D].clone(), h[..., D:].clone())
    h = a * _sigmoid(b)
    pad = K // 2
    hp = _pad(h, ((0, 0), (pad, pad), (0, 0)))
    out = torch.zeros_like(h)
    for i in range(K):
        out = out + hp[:, i:i + T, :] * dw[i][None, None, :]
    return _silu(out) @ w_pw2
```

```asm
; @launch grid=(256,1,1) block=(512,1,1) lds=163840
.amdgcn_target "amdgcn-amd-amdhsa--gfx950"
.text
.globl standalone__conformer_conv_module__speech_kernel
.p2align 8
.type standalone__conformer_conv_module__speech_kernel,@function
standalone__conformer_conv_module__speech_kernel:
s_getpc_b64 s[54:55]
s_cmp_ge_u32 s2, 256
s_cbranch_scc1 L_end
s_load_dwordx8 s[36:43], s[0:1], 0
v_lshrrev_b32 v253, 6, v0
s_lshr_b32 s4, s2, 3
s_lshl_b32 s4, s4, 10
s_add_u32 s54, s54, s4
s_addc_u32 s55, s55, 0
v_lshlrev_b32 v2, 1, v0
v_and_b32 v2, 0x3c0, v2
v_mov_b32 v3, s55
v_add_co_u32 v2, vcc, s54, v2
v_readfirstlane_b32 s3, v253
v_and_b32 v255, 63, v0
v_addc_co_u32 v3, vcc, 0, v3, vcc
global_load_dword v203, v[2:3], off
s_and_b32 s4, s2, 127
s_mul_i32 s4, s4, 125
s_add_u32 s29, s4, 63
s_lshr_b32 s5, s2, 7
s_mul_i32 s5, s5, 8192000
s_and_b32 s34, s3, 3
s_mov_b32 s10, 8192000
s_mov_b32 s11, 0x20000
s_cmp_ge_u32 s3, 4
s_cbranch_scc1 L_Q
L_P:
v_lshrrev_b32 v253, 5, v255
v_and_b32 v254, 31, v255
v_xor_b32 v254, v254, v253
s_lshr_b32 s4, s2, 2
s_and_b32 s4, s4, 30
v_add_u32 v254, s4, v254
v_and_b32 v254, 31, v254
v_lshlrev_b32 v254, 4, v254
s_lshl_b32 s4, s34, 2
s_add_u32 s6, s29, s4
s_sub_u32 s7, s29, s4
s_sub_u32 s7, s7, 1
v_add_u32 v251, s6, v253
v_sub_u32 v252, s7, v253
v_lshl_add_u32 v251, v251, 9, v254
v_lshl_add_u32 v252, v252, 9, v254
s_mul_i32 s35, s34, 4224
s_waitcnt lgkmcnt(0)
s_add_u32 s8, s36, s5
s_addc_u32 s9, s37, 0
s_add_u32 m0, s35, 0
v_subrev_u32 v253, 0, v252
buffer_load_dwordx4 v253, s[8:11], 0 offen nt lds
s_add_u32 m0, s35, 1056
v_subrev_u32 v253, 1024, v252
buffer_load_dwordx4 v253, s[8:11], 0 offen nt lds
s_add_u32 m0, s35, 2112
v_add_u32 v253, 0, v251
buffer_load_dwordx4 v253, s[8:11], 0 offen nt lds
s_add_u32 m0, s35, 3168
v_add_u32 v253, 1024, v251
buffer_load_dwordx4 v253, s[8:11], 0 offen nt lds
s_mov_b64 s[12:13], s[38:39]
s_mov_b32 s14, 262144
s_mov_b32 s15, 0x20000
s_mov_b64 s[16:17], s[42:43]
s_mov_b32 s18, 131072
s_mov_b32 s19, 0x20000
s_mov_b64 s[24:25], s[40:41]
s_mov_b32 s26, 1536
s_mov_b32 s27, 0x20000
v_and_b32 v253, 1, v255
v_lshlrev_b32 v253, 6, v253
s_lshl_b32 s6, s2, 2
s_add_u32 s6, s6, s34
s_lshl_b32 s7, s6, 7
s_lshr_b32 s4, s6, 1
s_lshl_b32 s4, s4, 9
s_and_b32 s6, s6, 1
s_lshl_b32 s6, s6, 7
s_add_u32 s6, s6, s4
s_mov_b64 exec, 3
buffer_load_dword v243, v253, s[12:15], s6 offen offset:256
buffer_load_dword v244, v253, s[16:19], s7 offen
buffer_load_dword v209, v253, s[24:27], s7 offen
s_mov_b64 exec, -1
s_add_u32 m0, s35, 16896
v_subrev_u32 v253, 8192, v252
buffer_load_dwordx4 v253, s[8:11], 0 offen nt lds
s_add_u32 m0, s35, 17952
v_subrev_u32 v253, 9216, v252
buffer_load_dwordx4 v253, s[8:11], 0 offen nt lds
s_add_u32 m0, s35, 19008
v_add_u32 v253, 8192, v251
buffer_load_dwordx4 v253, s[8:11], 0 offen nt lds
s_add_u32 m0, s35, 20064
v_add_u32 v253, 9216, v251
buffer_load_dwordx4 v253, s[8:11], 0 offen nt lds
s_load_dwordx2 s[44:45], s[0:1], 32
s_mov_b32 s28, 0xbfb8aa3b
s_lshl_b32 s33, s3, 6
v_lshrrev_b32 v253, 2, v255
v_and_b32 v254, 3, v255
v_lshlrev_b32 v254, 4, v254
v_lshl_add_u32 v250, v253, 10, v254
v_add_u32 v250, s33, v250
v_add_u32 v208, 512, v250
s_lshr_b32 s101, s2, 3
s_lshl_b32 s101, s101, 14
s_mul_i32 s30, s34, 14336
s_add_u32 s30, s30, 41984
v_bfe_u32 v253, v255, 2, 2
v_lshlrev_b32 v249, 6, v253
v_bfe_u32 v253, v255, 4, 1
v_lshl_add_u32 v249, v253, 5, v249
v_lshrrev_b32 v253, 5, v255
v_lshl_add_u32 v249, v253, 9, v249
v_and_b32 v253, 3, v255
v_lshl_add_u32 v249, v253, 3, v249
v_add_u32 v249, s30, v249
s_add_u32 m0, s30, 0
s_and_b32 s100, s101, 0x3ffff
buffer_load_dwordx4 v250, s[12:15], s100 offen lds
s_add_u32 m0, s30, 1024
s_add_u32 s101, s100, 16384
buffer_load_dwordx4 v208, s[12:15], s100 offen lds
v_bfe_u32 v253, v255, 1, 4
v_mul_u32_u24 v245, 1056, v253
v_and_b32 v253, 1, v255
v_lshl_add_u32 v245, v253, 9, v245
v_lshrrev_b32 v254, 5, v255
v_xor_b32 v253, v253, v254
v_lshl_add_u32 v245, v253, 4, v245
s_lshl_b32 s31, s3, 11
s_add_u32 s31, s31, 0
v_and_b32 v253, 31, v255
v_lshl_add_u32 v246, v253, 6, s31
v_bfe_u32 v253, v255, 1, 2
v_lshlrev_b32 v247, 1, v254
v_xor_b32 v253, v253, v247
v_lshl_add_u32 v246, v253, 4, v246
v_xor_b32 v247, 16, v246
v_and_b32 v198, 7, v255
v_lshlrev_b32 v198, 2, v198
v_add_u32 v198, 161792, v198
s_lshl_b32 s4, s3, 2
s_add_u32 s4, s4, 161792
v_mov_b32 v199, s4
v_mov_b32 v201, 0
ds_write_b32 v199, v201
s_waitcnt lgkmcnt(0)
s_add_u32 s20, s44, s5
s_addc_u32 s21, s45, 0
s_mov_b32 s22, 8192000
s_mov_b32 s23, 0x20000
v_lshrrev_b32 v254, 5, v255
v_bfe_u32 v253, v255, 2, 2
v_lshl_add_u32 v253, v254, 2, v253
v_lshlrev_b32 v248, 6, v253
v_lshrrev_b32 v253, 1, v253
v_bfe_u32 v254, v255, 4, 1
v_lshlrev_b32 v254, 1, v254
v_xor_b32 v253, v253, v254
v_bfe_u32 v254, v255, 1, 1
v_xor_b32 v253, v253, v254
v_lshl_add_u32 v248, v253, 4, v248
v_and_b32 v253, 1, v255
v_lshl_add_u32 v248, v253, 3, v248
v_add_u32 v248, 0, v248
v_lshrrev_b32 v253, 3, v255
v_and_b32 v254, 7, v255
v_lshlrev_b32 v254, 4, v254
s_lshl_b32 s4, s34, 7
v_add_u32 v254, s4, v254
s_sub_u32 s6, s29, 1
s_sub_u32 s7, s29, 56
v_add_u32 v196, s6, v253
v_sub_u32 v197, s7, v253
v_lshl_add_u32 v196, v196, 9, v254
v_lshl_add_u32 v197, v197, 9, v254
s_mul_i32 s4, s34, 4608
s_add_u32 s4, s4, 66560
v_and_b32 v253, 31, v255
v_mul_u32_u24 v194, 144, v253
v_lshrrev_b32 v253, 5, v255
v_lshl_add_u32 v194, v253, 4, v194
v_add_u32 v194, s4, v194
v_lshrrev_b32 v253, 3, v255
v_mul_u32_u24 v195, 144, v253
v_and_b32 v253, 7, v255
v_lshl_add_u32 v195, v253, 4, v195
v_add_u32 v195, s4, v195
s_lshl_b32 s52, s34, 10
s_lshl_b32 s53, s34, 7
v_lshrrev_b32 v253, 2, v255
v_and_b32 v254, 3, v255
v_lshlrev_b32 v254, 4, v254
v_lshl_add_u32 v192, v253, 9, v254
v_bfe_u32 v253, v255, 2, 2
v_lshlrev_b32 v193, 6, v253
v_bfe_u32 v253, v255, 4, 1
v_lshl_add_u32 v193, v253, 5, v193
v_lshrrev_b32 v253, 5, v255
v_lshl_add_u32 v193, v253, 8, v193
v_and_b32 v253, 1, v255
v_lshl_add_u32 v193, v253, 4, v193
v_bfe_u32 v253, v255, 1, 1
v_lshl_add_u32 v193, v253, 3, v193
v_add_u32 v193, s52, v193
s_add_u32 s52, s52, 100352
v_add_u32 v204, 8192, v193
v_add_u32 v193, 100352, v193
s_add_u32 m0, s30, 2048
s_and_b32 s100, s101, 0x3ffff
buffer_load_dwordx4 v250, s[12:15], s100 offen lds
s_add_u32 m0, s30, 3072
s_add_u32 s101, s100, 16384
buffer_load_dwordx4 v208, s[12:15], s100 offen lds
s_add_u32 m0, s30, 4096
s_and_b32 s100, s101, 0x3ffff
buffer_load_dwordx4 v250, s[12:15], s100 offen lds
s_add_u32 m0, s30, 5120
s_add_u32 s101, s100, 16384
buffer_load_dwordx4 v208, s[12:15], s100 offen lds
s_add_u32 m0, s30, 6144
s_and_b32 s100, s101, 0x3ffff
buffer_load_dwordx4 v250, s[12:15], s100 offen lds
s_add_u32 m0, s30, 7168
s_add_u32 s101, s100, 16384
buffer_load_dwordx4 v208, s[12:15], s100 offen lds
s_waitcnt vmcnt(8) lgkmcnt(0)
L_ordJ:
s_barrier
ds_read_b128 v[224:227], v245 offset:0
ds_read_b128 v[228:231], v245 offset:16896
ds_read_b128 v[232:235], v245 offset:32
ds_read_b128 v[236:239], v245 offset:16928
s_add_u32 m0, s30, 8192
s_and_b32 s100, s101, 0x3ffff
buffer_load_dwordx4 v250, s[12:15], s100 offen lds
s_add_u32 m0, s30, 9216
s_add_u32 s101, s100, 16384
buffer_load_dwordx4 v208, s[12:15], s100 offen lds
s_add_u32 m0, s30, 10240
s_and_b32 s100, s101, 0x3ffff
buffer_load_dwordx4 v250, s[12:15], s100 offen lds
s_add_u32 m0, s30, 11264
s_add_u32 s101, s100, 16384
buffer_load_dwordx4 v208, s[12:15], s100 offen lds
s_add_u32 m0, s30, 12288
s_and_b32 s100, s101, 0x3ffff
buffer_load_dwordx4 v250, s[12:15], s100 offen lds
s_add_u32 m0, s30, 13312
s_add_u32 s101, s100, 16384
buffer_load_dwordx4 v208, s[12:15], s100 offen lds
s_waitcnt vmcnt(13)
ds_read_b64_tr_b16 v[0:1], v249 offset:0
ds_read_b64_tr_b16 v[2:3], v249 offset:256
s_waitcnt vmcnt(12)
ds_read_b64_tr_b16 v[4:5], v249 offset:1024
ds_read_b64_tr_b16 v[6:7], v249 offset:1280
s_waitcnt vmcnt(11)
ds_read_b64_tr_b16 v[8:9], v249 offset:2048
ds_read_b64_tr_b16 v[10:11], v249 offset:2304
s_waitcnt lgkmcnt(2)
v_mfma_f32_32x32x16_bf16 v[144:159], v[224:227], v[4:7], 0
s_add_u32 m0, s30, 0
s_and_b32 s100, s101, 0x3ffff
buffer_load_dwordx4 v250, s[12:15], s100 offen lds
s_waitcnt vmcnt(11)
ds_read_b64_tr_b16 v[12:13], v249 offset:3072
v_mfma_f32_32x32x16_bf16 v[128:143], v[224:227], v[0:3], 0
ds_read_b128 v[224:227], v245 offset:64
ds_read_b64_tr_b16 v[14:15], v249 offset:3328
v_mfma_f32_32x32x16_bf16 v[176:191], v[228:231], v[4:7], 0
s_add_u32 m0, s30, 1024
s_add_u32 s101, s100, 16384
buffer_load_dwordx4 v208, s[12:15], s100 offen lds
s_waitcnt vmcnt(11)
ds_read_b64_tr_b16 v[16:17], v249 offset:4096
v_mfma_f32_32x32x16_bf16 v[160:175], v[228:231], v[0:3], 0
ds_read_b128 v[228:231], v245 offset:16960
ds_read_b64_tr_b16 v[18:19], v249 offset:4352
s_waitcnt lgkmcnt(3)
v_mfma_f32_32x32x16_bf16 v[144:159], v[232:235], v[12:15], v[144:159]
s_add_u32 m0, s30, 2048
s_and_b32 s100, s101, 0x3ffff
buffer_load_dwordx4 v250, s[12:15], s100 offen lds
s_waitcnt vmcnt(11)
ds_read_b64_tr_b16 v[20:21], v249 offset:5120
v_mfma_f32_32x32x16_bf16 v[128:143], v[232:235], v[8:11], v[128:143]
ds_read_b128 v[232:235], v245 offset:96
ds_read_b64_tr_b16 v[22:23], v249 offset:5376
v_mfma_f32_32x32x16_bf16 v[176:191], v[236:239], v[12:15], v[176:191]
s_add_u32 m0, s30, 3072
s_add_u32 s101, s100, 16384
buffer_load_dwordx4 v208, s[12:15], s100 offen lds
s_waitcnt vmcnt(11)
ds_read_b64_tr_b16 v[24:25], v249 offset:6144
v_mfma_f32_32x32x16_bf16 v[160:175], v[236:239], v[8:11], v[160:175]
ds_read_b128 v[236:239], v245 offset:16992
ds_read_b64_tr_b16 v[26:27], v249 offset:6400
s_waitcnt lgkmcnt(3)
v_mfma_f32_32x32x16_bf16 v[144:159], v[224:227], v[20:23], v[144:159]
s_add_u32 m0, s30, 4096
s_and_b32 s100, s101, 0x3ffff
buffer_load_dwordx4 v250, s[12:15], s100 offen lds
s_waitcnt vmcnt(11)
ds_read_b64_tr_b16 v[28:29], v249 offset:7168
v_mfma_f32_32x32x16_bf16 v[128:143], v[224:227], v[16:19], v[128:143]
ds_read_b128 v[224:227], v245 offset:128
ds_read_b64_tr_b16 v[30:31], v249 offset:7424
v_mfma_f32_32x32x16_bf16 v[176:191], v[228:231], v[20:23], v[176:191]
s_add_u32 m0, s30, 5120
s_add_u32 s101, s100, 16384
buffer_load_dwordx4 v208, s[12:15], s100 offen lds
s_waitcnt vmcnt(11)
ds_read_b64_tr_b16 v[32:33], v249 offset:8192
v_mfma_f32_32x32x16_bf16 v[160:175], v[228:231], v[16:19], v[160:175]
ds_read_b128 v[228:231], v245 offset:17024
ds_read_b64_tr_b16 v[34:35], v249 offset:8448
s_waitcnt lgkmcnt(3)
v_mfma_f32_32x32x16_bf16 v[144:159], v[232:235], v[28:31], v[144:159]
s_add_u32 m0, s30, 6144
s_and_b32 s100, s101, 0x3ffff
buffer_load_dwordx4 v250, s[12:15], s100 offen lds
s_waitcnt vmcnt(11)
ds_read_b64_tr_b16 v[36:37], v249 offset:9216
v_mfma_f32_32x32x16_bf16 v[128:143], v[232:235], v[24:27], v[128:143]
ds_read_b128 v[232:235], v245 offset:160
ds_read_b64_tr_b16 v[38:39], v249 offset:9472
v_mfma_f32_32x32x16_bf16 v[176:191], v[236:239], v[28:31], v[176:191]
s_add_u32 m0, s30, 7168
s_add_u32 s101, s100, 16384
buffer_load_dwordx4 v208, s[12:15], s100 offen lds
s_waitcnt vmcnt(11)
ds_read_b64_tr_b16 v[40:41], v249 offset:10240
v_mfma_f32_32x32x16_bf16 v[160:175], v[236:239], v[24:27], v[160:175]
ds_read_b128 v[236:239], v245 offset:17056
ds_read_b64_tr_b16 v[42:43], v249 offset:10496
s_waitcnt lgkmcnt(3)
v_mfma_f32_32x32x16_bf16 v[144:159], v[224:227], v[36:39], v[144:159]
s_add_u32 m0, s30, 8192
s_and_b32 s100, s101, 0x3ffff
buffer_load_dwordx4 v250, s[12:15], s100 offen lds
s_waitcnt vmcnt(11)
ds_read_b64_tr_b16 v[44:45], v249 offset:11264
v_mfma_f32_32x32x16_bf16 v[128:143], v[224:227], v[32:35], v[128:143]
ds_read_b128 v[224:227], v245 offset:192
ds_read_b64_tr_b16 v[46:47], v249 offset:11520
v_mfma_f32_32x32x16_bf16 v[176:191], v[228:231], v[36:39], v[176:191]
s_add_u32 m0, s30, 9216
s_add_u32 s101, s100, 16384
buffer_load_dwordx4 v208, s[12:15], s100 offen lds
s_waitcnt vmcnt(11)
ds_read_b64_tr_b16 v[48:49], v249 offset:12288
v_mfma_f32_32x32x16_bf16 v[160:175], v[228:231], v[32:35], v[160:175]
ds_read_b128 v[228:231], v245 offset:17088
ds_read_b64_tr_b16 v[50:51], v249 offset:12544
s_waitcnt lgkmcnt(3)
v_mfma_f32_32x32x16_bf16 v[144:159], v[232:235], v[44:47], v[144:159]
s_add_u32 m0, s30, 10240
s_and_b32 s100, s101, 0x3ffff
buffer_load_dwordx4 v250, s[12:15], s100 offen lds
s_waitcnt vmcnt(11)
ds_read_b64_tr_b16 v[52:53], v249 offset:13312
v_mfma_f32_32x32x16_bf16 v[128:143], v[232:235], v[40:43], v[128:143]
ds_read_b128 v[232:235], v245 offset:224
ds_read_b64_tr_b16 v[54:55], v249 offset:13568
v_mfma_f32_32x32x16_bf16 v[176:191], v[236:239], v[44:47], v[176:191]
s_add_u32 m0, s30, 11264
s_add_u32 s101, s100, 16384
buffer_load_dwordx4 v208, s[12:15], s100 offen lds
s_waitcnt vmcnt(11)
ds_read_b64_tr_b16 v[56:57], v249 offset:0
v_mfma_f32_32x32x16_bf16 v[160:175], v[236:239], v[40:43], v[160:175]
ds_read_b128 v[236:239], v245 offset:17120
ds_read_b64_tr_b16 v[58:59], v249 offset:256
s_waitcnt lgkmcnt(3)
v_mfma_f32_32x32x16_bf16 v[144:159], v[224:227], v[52:55], v[144:159]
s_add_u32 m0, s30, 12288
s_and_b32 s100, s101, 0x3ffff
buffer_load_dwordx4 v250, s[12:15], s100 offen lds
s_waitcnt vmcnt(11)
ds_read_b64_tr_b16 v[60:61], v249 offset:1024
v_mfma_f32_32x32x16_bf16 v[128:143], v[224:227], v[48:51], v[128:143]
ds_read_b128 v[224:227], v245 offset:256
ds_read_b64_tr_b16 v[62:63], v249 offset:1280
v_mfma_f32_32x32x16_bf16 v[176:191], v[228:231], v[52:55], v[176:191]
s_add_u32 m0, s30, 13312
s_add_u32 s101, s100, 16384
buffer_load_dwordx4 v208, s[12:15], s100 offen lds
s_barrier
s_waitcnt vmcnt(11)
ds_read_b64_tr_b16 v[64:65], v249 offset:2048
v_mfma_f32_32x32x16_bf16 v[160:175], v[228:231], v[48:51], v[160:175]
ds_read_b128 v[228:231], v245 offset:17152
ds_read_b64_tr_b16 v[66:67], v249 offset:2304
s_waitcnt lgkmcnt(3)
v_mfma_f32_32x32x16_bf16 v[144:159], v[232:235], v[60:63], v[144:159]
s_add_u32 m0, s30, 0
s_and_b32 s100, s101, 0x3ffff
buffer_load_dwordx4 v250, s[12:15], s100 offen lds
s_waitcnt vmcnt(11)
ds_read_b64_tr_b16 v[68:69], v249 offset:3072
v_mfma_f32_32x32x16_bf16 v[128:143], v[232:235], v[56:59], v[128:143]
ds_read_b128 v[232:235], v245 offset:288
ds_read_b64_tr_b16 v[70:71], v249 offset:3328
v_mfma_f32_32x32x16_bf16 v[176:191], v[236:239], v[60:63], v[176:191]
s_add_u32 m0, s30, 1024
s_add_u32 s101, s100, 16384
buffer_load_dwordx4 v208, s[12:15], s100 offen lds
s_waitcnt vmcnt(11)
ds_read_b64_tr_b16 v[72:73], v249 offset:4096
v_mfma_f32_32x32x16_bf16 v[160:175], v[236:239], v[56:59], v[160:175]
ds_read_b128 v[236:239], v245 offset:17184
ds_read_b64_tr_b16 v[74:75], v249 offset:4352
s_waitcnt lgkmcnt(3)
v_mfma_f32_32x32x16_bf16 v[144:159], v[224:227], v[68:71], v[144:159]
s_add_u32 m0, s30, 2048
s_and_b32 s100, s101, 0x3ffff
buffer_load_dwordx4 v250, s[12:15], s100 offen lds
s_waitcnt vmcnt(11)
ds_read_b64_tr_b16 v[76:77], v249 offset:5120
v_mfma_f32_32x32x16_bf16 v[128:143], v[224:227], v[64:67], v[128:143]
ds_read_b128 v[224:227], v245 offset:320
ds_read_b64_tr_b16 v[78:79], v249 offset:5376
v_mfma_f32_32x32x16_bf16 v[176:191], v[228:231], v[68:71], v[176:191]
s_add_u32 m0, s30, 3072
s_add_u32 s101, s100, 16384
buffer_load_dwordx4 v208, s[12:15], s100 offen lds
s_waitcnt vmcnt(11)
ds_read_b64_tr_b16 v[80:81], v249 offset:6144
v_mfma_f32_32x32x16_bf16 v[160:175], v[228:231], v[64:67], v[160:175]
ds_read_b128 v[228:231], v245 offset:17216
ds_read_b64_tr_b16 v[82:83], v249 offset:6400
s_waitcnt lgkmcnt(3)
v_mfma_f32_32x32x16_bf16 v[144:159], v[232:235], v[76:79], v[144:159]
s_waitcnt vmcnt(10)
ds_read_b64_tr_b16 v[84:85], v249 offset:7168
v_and_b32 v253, 31, v255
v_lshlrev_b32 v253, 1, v253
buffer_load_ushort v241, v253, s[24:27], s33 offen offset:0
buffer_load_ushort v240, v253, s[24:27], s33 offen offset:512
buffer_load_ushort v242, v253, s[24:27], s33 offen offset:1024
v_mfma_f32_32x32x16_bf16 v[128:143], v[232:235], v[72:75], v[128:143]
ds_read_b128 v[232:235], v245 offset:352
ds_read_b64_tr_b16 v[86:87], v249 offset:7424
v_mfma_f32_32x32x16_bf16 v[176:191], v[236:239], v[76:79], v[176:191]
s_waitcnt vmcnt(12)
ds_read_b64_tr_b16 v[88:89], v249 offset:8192
ds_read_b64_tr_b16 v[90:91], v249 offset:8448
v_mfma_f32_32x32x16_bf16 v[160:175], v[236:239], v[72:75], v[160:175]
ds_read_b128 v[236:239], v245 offset:17248
s_waitcnt lgkmcnt(3)
v_mfma_f32_32x32x16_bf16 v[144:159], v[224:227], v[84:87], v[144:159]
s_waitcnt vmcnt(11)
ds_read_b64_tr_b16 v[92:93], v249 offset:9216
s_waitcnt vmcnt(0)
ds_read_b64_tr_b16 v[94:95], v249 offset:9472
v_mfma_f32_32x32x16_bf16 v[128:143], v[224:227], v[80:83], v[128:143]
ds_read_b128 v[224:227], v245 offset:384
v_lshlrev_b32 v241, 16, v241
v_mfma_f32_32x32x16_bf16 v[176:191], v[228:231], v[84:87], v[176:191]
ds_read_b64_tr_b16 v[96:97], v249 offset:10240
v_lshlrev_b32 v240, 16, v240
ds_read_b64_tr_b16 v[98:99], v249 offset:10496
v_mfma_f32_32x32x16_bf16 v[160:175], v[228:231], v[80:83], v[160:175]
ds_read_b128 v[228:231], v245 offset:17280
v_lshlrev_b32 v242, 16, v242
s_waitcnt lgkmcnt(4)
v_mfma_f32_32x32x16_bf16 v[144:159], v[232:235], v[92:95], v[144:159]
ds_read_b64_tr_b16 v[100:101], v249 offset:11264
v_cmp_gt_u32 vcc, 32, v255
ds_read_b64_tr_b16 v[102:103], v249 offset:11520
v_mfma_f32_32x32x16_bf16 v[128:143], v[232:235], v[88:91], v[128:143]
ds_read_b128 v[232:235], v245 offset:416
v_mul_f32 v241, s28, v241
v_mfma_f32_32x32x16_bf16 v[176:191], v[236:239], v[92:95], v[176:191]
ds_read_b64_tr_b16 v[104:105], v249 offset:12288
v_mul_f32 v240, s28, v240
ds_read_b64_tr_b16 v[106:107], v249 offset:12544
v_mfma_f32_32x32x16_bf16 v[160:175], v[236:239], v[88:91], v[160:175]
ds_read_b128 v[236:239], v245 offset:17312
v_mul_f32 v242, s28, v242
s_waitcnt lgkmcnt(4)
v_mfma_f32_32x32x16_bf16 v[144:159], v[224:227], v[100:103], v[144:159]
ds_read_b64_tr_b16 v[108:109], v249 offset:13312
v_cndmask_b32 v201, v241, v242, vcc
ds_read_b64_tr_b16 v[110:111], v249 offset:13568
v_mfma_f32_32x32x16_bf16 v[128:143], v[224:227], v[96:99], v[128:143]
ds_read_b128 v[224:227], v245 offset:448
v_cndmask_b32 v242, v242, v241, vcc
v_mfma_f32_32x32x16_bf16 v[176:191], v[228:231], v[100:103], v[176:191]
ds_read_b64_tr_b16 v[112:113], v249 offset:0
v_mov_b32 v241, v201
ds_read_b64_tr_b16 v[114:115], v249 offset:256
v_mfma_f32_32x32x16_bf16 v[160:175], v[228:231], v[96:99], v[160:175]
ds_read_b128 v[228:231], v245 offset:17344
v_max_f32 v201, abs(v241), abs(v242)
s_waitcnt lgkmcnt(4)
v_mfma_f32_32x32x16_bf16 v[144:159], v[232:235], v[108:111], v[144:159]
ds_read_b64_tr_b16 v[116:117], v249 offset:1024
v_mul_f32 v201, 0x30800000, v201
ds_read_b64_tr_b16 v[118:119], v249 offset:1280
v_mfma_f32_32x32x16_bf16 v[128:143], v[232:235], v[104:107], v[128:143]
ds_read_b128 v[232:235], v245 offset:480
v_max_f32 v201, 0x2b800000, v201
v_mfma_f32_32x32x16_bf16 v[176:191], v[236:239], v[108:111], v[176:191]
ds_read_b64_tr_b16 v[120:121], v249 offset:2048
v_cmp_nge_f32 s[48:49], abs(v240), v201
ds_read_b64_tr_b16 v[122:123], v249 offset:2304
v_mfma_f32_32x32x16_bf16 v[160:175], v[236:239], v[104:107], v[160:175]
ds_read_b128 v[236:239], v245 offset:17376
v_mov_b32 v201, 0x53800000
s_waitcnt lgkmcnt(4)
v_mfma_f32_32x32x16_bf16 v[144:159], v[224:227], v[116:119], v[144:159]
ds_read_b64_tr_b16 v[124:125], v249 offset:3072
v_cmp_nle_f32 s[50:51], abs(v240), v201
ds_read_b64_tr_b16 v[126:127], v249 offset:3328
v_mfma_f32_32x32x16_bf16 v[128:143], v[224:227], v[112:115], v[128:143]
v_rcp_f32 v201, v240
v_mfma_f32_32x32x16_bf16 v[176:191], v[228:231], v[116:119], v[176:191]
s_nop 3
s_or_b64 s[48:49], s[48:49], s[50:51]
s_cselect_b64 vcc, -1, 0
s_cselect_b32 s32, 1, 0
v_mfma_f32_32x32x16_bf16 v[160:175], v[228:231], v[112:115], v[160:175]
v_cndmask_b32 v240, v201, v240, vcc
s_waitcnt lgkmcnt(0)
v_mfma_f32_32x32x16_bf16 v[144:159], v[232:235], v[124:127], v[144:159]
v_cndmask_b32 v201, v201, 1.0, vcc
v_mfma_f32_32x32x16_bf16 v[128:143], v[232:235], v[120:123], v[128:143]
v_mul_f32 v241, v241, v201
v_mfma_f32_32x32x16_bf16 v[176:191], v[236:239], v[124:127], v[176:191]
v_mul_f32 v242, v242, v201
v_mfma_f32_32x32x16_bf16 v[160:175], v[236:239], v[120:123], v[160:175]
v_mov_b32 v201, 5
ds_write_b32 v199, v201
s_cmp_lg_u32 s32, 0
s_cbranch_scc1 L_slowP
s_nop 4
v_mul_f32 v144, s28, v144
v_mul_f32 v145, s28, v145
v_mul_f32 v146, s28, v146
v_mul_f32 v147, s28, v147
v_mul_f32 v148, s28, v148
v_mul_f32 v149, s28, v149
v_mul_f32 v150, s28, v150
v_mul_f32 v151, s28, v151
v_mul_f32 v152, s28, v152
v_mul_f32 v153, s28, v153
v_mul_f32 v154, s28, v154
v_mul_f32 v155, s28, v155
v_mul_f32 v156, s28, v156
v_mul_f32 v157, s28, v157
v_mul_f32 v158, s28, v158
v_mul_f32 v159, s28, v159
v_exp_f32 v144, v144
v_exp_f32 v145, v145
v_exp_f32 v146, v146
v_exp_f32 v147, v147
v_exp_f32 v148, v148
v_exp_f32 v149, v149
v_exp_f32 v150, v150
v_exp_f32 v151, v151
v_exp_f32 v152, v152
v_exp_f32 v153, v153
v_exp_f32 v154, v154
v_exp_f32 v155, v155
v_exp_f32 v156, v156
v_exp_f32 v157, v157
v_exp_f32 v158, v158
v_exp_f32 v159, v159
v_fma_f32 v144, v144, v240, v240
v_fma_f32 v145, v145, v240, v240
v_fma_f32 v146, v146, v240, v240
v_fma_f32 v147, v147, v240, v240
v_fma_f32 v148, v148, v240, v240
v_fma_f32 v149, v149, v240, v240
v_fma_f32 v150, v150, v240, v240
v_fma_f32 v151, v151, v240, v240
v_fma_f32 v152, v152, v240, v240
v_fma_f32 v153, v153, v240, v240
v_fma_f32 v154, v154, v240, v240
v_fma_f32 v155, v155, v240, v240
v_fma_f32 v156, v156, v240, v240
v_fma_f32 v157, v157, v240, v240
v_fma_f32 v158, v158, v240, v240
v_fma_f32 v159, v159, v240, v240
v_rcp_f32 v144, v144
v_rcp_f32 v145, v145
v_rcp_f32 v146, v146
v_rcp_f32 v147, v147
v_rcp_f32 v148, v148
v_rcp_f32 v149, v149
v_rcp_f32 v150, v150
v_rcp_f32 v151, v151
v_rcp_f32 v152, v152
v_rcp_f32 v153, v153
v_rcp_f32 v154, v154
v_rcp_f32 v155, v155
v_rcp_f32 v156, v156
v_rcp_f32 v157, v157
v_rcp_f32 v158, v158
v_rcp_f32 v159, v159
v_mul_f32 v128, v128, v144
v_mul_f32 v129, v129, v145
v_mov_b32 v243, v128
v_mov_b32 v244, v128
v_cmp_gt_u32 vcc, 32, v255
v_mul_f32 v130, v130, v146
v_mul_f32 v131, v131, v147
v_mul_f32 v132, v132, v148
v_permlane32_swap_b32 v243, v244
v_mul_f32 v133, v133, v149
v_mul_f32 v134, v134, v150
v_mul_f32 v135, v135, v151
v_cndmask_b32 v244, v243, v244, vcc
v_mul_f32 v136, v136, v152
v_mul_f32 v137, v137, v153
v_mul_f32 v138, v138, v154
v_mul_f32 v139, v139, v155
v_mul_f32 v140, v140, v156
v_mul_f32 v141, v141, v157
v_mul_f32 v202, v142, v158
v_mul_f32 v203, v143, v159
v_fma_f32 v144, v242, v128, v244
v_fma_f32 v145, v242, v129, v128
v_fma_f32 v146, v242, v130, v129
v_fma_f32 v147, v242, v131, v130
v_fma_f32 v148, v242, v132, v131
v_fma_f32 v149, v242, v133, v132
v_fma_f32 v150, v242, v134, v133
v_fma_f32 v151, v242, v135, v134
v_fma_f32 v152, v242, v136, v135
v_fma_f32 v153, v242, v137, v136
v_fma_f32 v154, v242, v138, v137
v_fma_f32 v155, v242, v139, v138
v_fma_f32 v156, v242, v140, v139
v_fma_f32 v157, v242, v141, v140
v_fma_f32 v158, v242, v202, v141
v_fma_f32 v159, v242, v203, v202
v_fmac_f32 v144, v241, v243
v_fmac_f32 v145, v241, v244
v_fmac_f32 v146, v241, v128
v_fmac_f32 v147, v241, v129
v_fmac_f32 v148, v241, v130
v_fmac_f32 v149, v241, v131
v_fmac_f32 v150, v241, v132
v_fmac_f32 v151, v241, v133
v_fmac_f32 v152, v241, v134
v_fmac_f32 v153, v241, v135
v_fmac_f32 v154, v241, v136
v_fmac_f32 v155, v241, v137
v_fmac_f32 v156, v241, v138
v_fmac_f32 v157, v241, v139
v_fmac_f32 v158, v241, v140
v_fmac_f32 v159, v241, v141
v_exp_f32 v128, v144
v_exp_f32 v129, v145
v_exp_f32 v130, v146
v_exp_f32 v131, v147
v_exp_f32 v132, v148
v_exp_f32 v133, v149
v_exp_f32 v134, v150
v_exp_f32 v135, v151
v_fma_f32 v128, v128, s28, s28
v_fma_f32 v129, v129, s28, s28
v_fma_f32 v130, v130, s28, s28
v_fma_f32 v131, v131, s28, s28
v_fma_f32 v132, v132, s28, s28
v_fma_f32 v133, v133, s28, s28
v_fma_f32 v134, v134, s28, s28
v_fma_f32 v135, v135, s28, s28
v_rcp_f32 v128, v128
v_rcp_f32 v129, v129
v_rcp_f32 v130, v130
v_rcp_f32 v131, v131
v_rcp_f32 v132, v132
v_rcp_f32 v133, v133
v_rcp_f32 v134, v134
v_rcp_f32 v135, v135
v_mul_f32 v144, v144, v128
v_mul_f32 v145, v145, v129
v_mul_f32 v146, v146, v130
v_mul_f32 v147, v147, v131
v_mul_f32 v148, v148, v132
v_mul_f32 v149, v149, v133
v_mul_f32 v150, v150, v134
v_mul_f32 v151, v151, v135
v_cvt_pk_bf16_f32 v128, v144, v145
v_cvt_pk_bf16_f32 v129, v146, v147
v_cvt_pk_bf16_f32 v130, v148, v149
v_cvt_pk_bf16_f32 v131, v150, v151
ds_write_b128 v246, v[128:131] offset:33792
v_exp_f32 v136, v152
v_exp_f32 v137, v153
v_exp_f32 v138, v154
v_exp_f32 v139, v155
v_exp_f32 v140, v156
v_exp_f32 v141, v157
v_exp_f32 v142, v158
v_exp_f32 v143, v159
v_fma_f32 v136, v136, s28, s28
v_fma_f32 v137, v137, s28, s28
v_fma_f32 v138, v138, s28, s28
v_fma_f32 v139, v139, s28, s28
v_fma_f32 v140, v140, s28, s28
v_fma_f32 v141, v141, s28, s28
v_fma_f32 v142, v142, s28, s28
v_fma_f32 v143, v143, s28, s28
v_rcp_f32 v136, v136
v_rcp_f32 v137, v137
v_rcp_f32 v138, v138
v_rcp_f32 v139, v139
v_rcp_f32 v140, v140
v_rcp_f32 v141, v141
v_rcp_f32 v142, v142
v_rcp_f32 v143, v143
v_mul_f32 v152, v152, v136
v_mul_f32 v153, v153, v137
v_mul_f32 v154, v154, v138
v_mul_f32 v155, v155, v139
v_mul_f32 v156, v156, v140
v_mul_f32 v157, v157, v141
v_mul_f32 v158, v158, v142
v_mul_f32 v159, v159, v143
v_cvt_pk_bf16_f32 v136, v152, v153
v_cvt_pk_bf16_f32 v137, v154, v155
v_cvt_pk_bf16_f32 v138, v156, v157
v_cvt_pk_bf16_f32 v139, v158, v159
ds_write_b128 v247, v[136:139] offset:33792
ds_read_b32 v200, v198
v_mul_f32 v176, s28, v176
v_mul_f32 v177, s28, v177
v_mul_f32 v178, s28, v178
v_mul_f32 v179, s28, v179
v_mul_f32 v180, s28, v180
v_mul_f32 v181, s28, v181
v_mul_f32 v182, s28, v182
v_mul_f32 v183, s28, v183
v_mul_f32 v184, s28, v184
v_mul_f32 v185, s28, v185
v_mul_f32 v186, s28, v186
v_mul_f32 v187, s28, v187
v_mul_f32 v188, s28, v188
v_mul_f32 v189, s28, v189
v_mul_f32 v190, s28, v190
v_mul_f32 v191, s28, v191
v_exp_f32 v176, v176
v_exp_f32 v177, v177
v_exp_f32 v178, v178
v_exp_f32 v179, v179
s_waitcnt lgkmcnt(0)
v_cmp_gt_u32 vcc, 5, v200
s_cbranch_vccnz L_waitP5
L_goP5:
v_exp_f32 v180, v180
v_exp_f32 v181, v181
v_exp_f32 v182, v182
v_exp_f32 v183, v183
v_exp_f32 v184, v184
v_exp_f32 v185, v185
v_exp_f32 v186, v186
v_exp_f32 v187, v187
v_exp_f32 v188, v188
v_exp_f32 v189, v189
v_exp_f32 v190, v190
v_exp_f32 v191, v191
v_fma_f32 v176, v176, v240, v240
v_fma_f32 v177, v177, v240, v240
v_fma_f32 v178, v178, v240, v240
v_fma_f32 v179, v179, v240, v240
v_fma_f32 v180, v180, v240, v240
v_fma_f32 v181, v181, v240, v240
v_fma_f32 v182, v182, v240, v240
v_fma_f32 v183, v183, v240, v240
v_fma_f32 v184, v184, v240, v240
v_fma_f32 v185, v185, v240, v240
v_fma_f32 v186, v186, v240, v240
v_fma_f32 v187, v187, v240, v240
v_fma_f32 v188, v188, v240, v240
v_fma_f32 v189, v189, v240, v240
v_fma_f32 v190, v190, v240, v240
v_fma_f32 v191, v191, v240, v240
v_rcp_f32 v176, v176
v_rcp_f32 v177, v177
v_rcp_f32 v178, v178
v_rcp_f32 v179, v179
v_rcp_f32 v180, v180
v_rcp_f32 v181, v181
v_rcp_f32 v182, v182
v_rcp_f32 v183, v183
v_rcp_f32 v184, v184
v_rcp_f32 v185, v185
v_rcp_f32 v186, v186
v_rcp_f32 v187, v187
v_rcp_f32 v188, v188
v_rcp_f32 v189, v189
v_rcp_f32 v190, v190
v_rcp_f32 v191, v191
v_mul_f32 v160, v160, v176
v_mul_f32 v161, v161, v177
v_mul_f32 v162, v162, v178
v_mul_f32 v163, v163, v179
v_mul_f32 v164, v164, v180
v_mul_f32 v165, v165, v181
v_mul_f32 v166, v166, v182
v_mul_f32 v167, v167, v183
v_mul_f32 v168, v168, v184
v_mul_f32 v169, v169, v185
v_mul_f32 v170, v170, v186
v_mul_f32 v171, v171, v187
v_mul_f32 v172, v172, v188
v_mul_f32 v173, v173, v189
v_mul_f32 v243, v174, v190
v_mul_f32 v244, v175, v191
v_fma_f32 v176, v242, v160, v203
v_fma_f32 v177, v242, v161, v160
v_fma_f32 v178, v242, v162, v161
v_fma_f32 v179, v242, v163, v162
v_fma_f32 v180, v242, v164, v163
v_fma_f32 v181, v242, v165, v164
v_fma_f32 v182, v242, v166, v165
v_fma_f32 v183, v242, v167, v166
v_fma_f32 v184, v242, v168, v167
v_fma_f32 v185, v242, v169, v168
v_fma_f32 v186, v242, v170, v169
v_fma_f32 v187, v242, v171, v170
v_fma_f32 v188, v242, v172, v171
v_fma_f32 v189, v242, v173, v172
v_fma_f32 v190, v242, v243, v173
v_fma_f32 v191, v242, v244, v243
v_fmac_f32 v176, v241, v202
v_fmac_f32 v177, v241, v203
v_fmac_f32 v178, v241, v160
v_fmac_f32 v179, v241, v161
v_fmac_f32 v180, v241, v162
v_fmac_f32 v181, v241, v163
v_fmac_f32 v182, v241, v164
v_fmac_f32 v183, v241, v165
v_fmac_f32 v184, v241, v166
v_fmac_f32 v185, v241, v167
v_fmac_f32 v186, v241, v168
v_fmac_f32 v187, v241, v169
v_fmac_f32 v188, v241, v170
v_fmac_f32 v189, v241, v171
v_fmac_f32 v190, v241, v172
v_fmac_f32 v191, v241, v173
v_exp_f32 v160, v176
v_exp_f32 v161, v177
v_exp_f32 v162, v178
v_exp_f32 v163, v179
v_exp_f32 v164, v180
v_exp_f32 v165, v181
v_exp_f32 v166, v182
v_exp_f32 v167, v183
v_fma_f32 v160, v160, s28, s28
v_fma_f32 v161, v161, s28, s28
v_fma_f32 v162, v162, s28, s28
v_fma_f32 v163, v163, s28, s28
v_fma_f32 v164, v164, s28, s28
v_fma_f32 v165, v165, s28, s28
v_fma_f32 v166, v166, s28, s28
v_fma_f32 v167, v167, s28, s28
v_rcp_f32 v160, v160
v_rcp_f32 v161, v161
v_rcp_f32 v162, v162
v_rcp_f32 v163, v163
v_rcp_f32 v164, v164
v_rcp_f32 v165, v165
v_rcp_f32 v166, v166
v_rcp_f32 v167, v167
v_mul_f32 v176, v176, v160
v_mul_f32 v177, v177, v161
v_mul_f32 v178, v178, v162
v_mul_f32 v179, v179, v163
v_mul_f32 v180, v180, v164
v_mul_f32 v181, v181, v165
v_mul_f32 v182, v182, v166
v_mul_f32 v183, v183, v167
v_cvt_pk_bf16_f32 v160, v176, v177
v_cvt_pk_bf16_f32 v161, v178, v179
v_cvt_pk_bf16_f32 v162, v180, v181
v_cvt_pk_bf16_f32 v163, v182, v183
ds_write_b128 v246, v[160:163] offset:50176
v_exp_f32 v168, v184
v_exp_f32 v169, v185
v_exp_f32 v170, v186
v_exp_f32 v171, v187
v_exp_f32 v172, v188
v_exp_f32 v173, v189
v_exp_f32 v174, v190
v_exp_f32 v175, v191
v_fma_f32 v168, v168, s28, s28
v_fma_f32 v169, v169, s28, s28
v_fma_f32 v170, v170, s28, s28
v_fma_f32 v171, v171, s28, s28
v_fma_f32 v172, v172, s28, s28
v_fma_f32 v173, v173, s28, s28
v_fma_f32 v174, v174, s28, s28
v_fma_f32 v175, v175, s28, s28
v_rcp_f32 v168, v168
v_rcp_f32 v169, v169
v_rcp_f32 v170, v170
v_rcp_f32 v171, v171
v_rcp_f32 v172, v172
v_rcp_f32 v173, v173
v_rcp_f32 v174, v174
v_rcp_f32 v175, v175
v_mul_f32 v184, v184, v168
v_mul_f32 v185, v185, v169
v_mul_f32 v186, v186, v170
v_mul_f32 v187, v187, v171
v_mul_f32 v188, v188, v172
v_mul_f32 v189, v189, v173
v_mul_f32 v190, v190, v174
v_mul_f32 v191, v191, v175
v_cvt_pk_bf16_f32 v168, v184, v185
v_cvt_pk_bf16_f32 v169, v186, v187
v_cvt_pk_bf16_f32 v170, v188, v189
v_cvt_pk_bf16_f32 v171, v190, v191
ds_write_b128 v247, v[168:171] offset:50176
v_mov_b32 v201, 20
ds_write_b32 v199, v201
ds_read_b32 v200, v198
s_waitcnt lgkmcnt(0)
v_cmp_gt_u32 vcc, 10, v200
s_cbranch_vccnz L_waitP10
L_goP10:
v_add_u32 v245, 66560, v245
ds_read_b128 v[224:227], v245 offset:0
ds_read_b128 v[228:231], v245 offset:32
ds_read_b128 v[232:235], v245 offset:64
ds_read_b128 v[236:239], v245 offset:96
s_waitcnt lgkmcnt(3)
v_mfma_f32_32x32x16_bf16 v[144:159], v[224:227], v[4:7], 0
s_add_u32 m0, s52, 0
s_add_u32 s31, s53, 0
buffer_load_dwordx4 v192, s[16:19], s31 offen lds
v_mfma_f32_32x32x16_bf16 v[128:143], v[224:227], v[0:3], 0
ds_read_b128 v[224:227], v245 offset:128
s_waitcnt lgkmcnt(3)
v_mfma_f32_32x32x16_bf16 v[144:159], v[228:231], v[12:15], v[144:159]
s_add_u32 m0, s52, 4096
s_add_u32 s31, s53, 64
buffer_load_dwordx4 v192, s[16:19], s31 offen lds
v_mfma_f32_32x32x16_bf16 v[128:143], v[228:231], v[8:11], v[128:143]
ds_read_b128 v[228:231], v245 offset:160
s_waitcnt lgkmcnt(3)
v_mfma_f32_32x32x16_bf16 v[144:159], v[232:235], v[20:23], v[144:159]
v_mfma_f32_32x32x16_bf16 v[128:143], v[232:235], v[16:19], v[128:143]
ds_read_b128 v[232:235], v245 offset:192
s_add_u32 m0, s52, 8192
s_add_u32 s31, s53, 8192
buffer_load_dwordx4 v192, s[16:19], s31 offen lds
s_waitcnt lgkmcnt(3)
v_mfma_f32_32x32x16_bf16 v[144:159], v[236:239], v[28:31], v[144:159]
v_mfma_f32_32x32x16_bf16 v[128:143], v[236:239], v[24:27], v[128:143]
ds_read_b128 v[236:239], v245 offset:224
s_add_u32 m0, s52, 12288
s_add_u32 s31, s53, 8256
buffer_load_dwordx4 v192, s[16:19], s31 offen lds
s_waitcnt lgkmcnt(3)
v_mfma_f32_32x32x16_bf16 v[144:159], v[224:227], v[36:39], v[144:159]
v_mfma_f32_32x32x16_bf16 v[128:143], v[224:227], v[32:35], v[128:143]
ds_read_b128 v[224:227], v245 offset:256
s_waitcnt lgkmcnt(3)
v_mfma_f32_32x32x16_bf16 v[144:159], v[228:231], v[44:47], v[144:159]
s_add_u32 m0, s52, 16384
s_add_u32 s31, s53, 16384
buffer_load_dwordx4 v192, s[16:19], s31 offen lds
v_mfma_f32_32x32x16_bf16 v[128:143], v[228:231], v[40:43], v[128:143]
ds_read_b128 v[228:231], v245 offset:288
s_waitcnt lgkmcnt(3)
v_mfma_f32_32x32x16_bf16 v[144:159], v[232:235], v[52:55], v[144:159]
s_add_u32 m0, s52, 20480
s_add_u32 s31, s53, 16448
buffer_load_dwordx4 v192, s[16:19], s31 offen lds
v_mfma_f32_32x32x16_bf16 v[128:143], v[232:235], v[48:51], v[128:143]
ds_read_b128 v[232:235], v245 offset:320
s_waitcnt lgkmcnt(3)
v_mfma_f32_32x32x16_bf16 v[144:159], v[236:239], v[60:63], v[144:159]
v_mfma_f32_32x32x16_bf16 v[128:143], v[236:239], v[56:59], v[128:143]
ds_read_b128 v[236:239], v245 offset:352
s_add_u32 m0, s52, 24576
s_add_u32 s31, s53, 24576
buffer_load_dwordx4 v192, s[16:19], s31 offen lds
s_waitcnt lgkmcnt(3)
v_mfma_f32_32x32x16_bf16 v[144:159], v[224:227], v[68:71], v[144:159]
v_mfma_f32_32x32x16_bf16 v[128:143], v[224:227], v[64:67], v[128:143]
ds_read_b128 v[224:227], v245 offset:384
s_add_u32 m0, s52, 28672
s_add_u32 s31, s53, 24640
buffer_load_dwordx4 v192, s[16:19], s31 offen lds
s_waitcnt lgkmcnt(3)
v_mfma_f32_32x32x16_bf16 v[144:159], v[228:231], v[76:79], v[144:159]
v_mfma_f32_32x32x16_bf16 v[128:143], v[228:231], v[72:75], v[128:143]
ds_read_b128 v[228:231], v245 offset:416
s_waitcnt lgkmcnt(3)
v_mfma_f32_32x32x16_bf16 v[144:159], v[232:235], v[84:87], v[144:159]
s_add_u32 m0, s52, 32768
s_add_u32 s31, s53, 32768
buffer_load_dwordx4 v192, s[16:19], s31 offen lds
v_mfma_f32_32x32x16_bf16 v[128:143], v[232:235], v[80:83], v[128:143]
ds_read_b32 v200, v198
ds_read_b128 v[232:235], v245 offset:448
s_waitcnt lgkmcnt(4)
v_mfma_f32_32x32x16_bf16 v[144:159], v[236:239], v[92:95], v[144:159]
s_add_u32 m0, s52, 36864
s_add_u32 s31, s53, 32832
buffer_load_dwordx4 v192, s[16:19], s31 offen lds
v_mfma_f32_32x32x16_bf16 v[128:143], v[236:239], v[88:91], v[128:143]
ds_read_b128 v[236:239], v245 offset:480
s_waitcnt lgkmcnt(2)
v_cmp_gt_u32 vcc, 20, v200
s_cbranch_vccnz L_waitP20
L_goP20:
v_mfma_f32_32x32x16_bf16 v[144:159], v[224:227], v[100:103], v[144:159]
v_mfma_f32_32x32x16_bf16 v[128:143], v[224:227], v[96:99], v[128:143]
ds_read_b128 v[224:227], v245 offset:16896
s_add_u32 m0, s52, 40960
s_add_u32 s31, s53, 40960
buffer_load_dwordx4 v192, s[16:19], s31 offen lds
v_mfma_f32_32x32x16_bf16 v[144:159], v[228:231], v[108:111], v[144:159]
v_mfma_f32_32x32x16_bf16 v[128:143], v[228:231], v[104:107], v[128:143]
ds_read_b128 v[228:231], v245 offset:16928
s_add_u32 m0, s52, 45056
s_add_u32 s31, s53, 41024
buffer_load_dwordx4 v192, s[16:19], s31 offen lds
s_waitcnt lgkmcnt(3)
v_mfma_f32_32x32x16_bf16 v[144:159], v[232:235], v[116:119], v[144:159]
v_mfma_f32_32x32x16_bf16 v[128:143], v[232:235], v[112:115], v[128:143]
ds_read_b128 v[232:235], v245 offset:16960
s_waitcnt lgkmcnt(3)
v_mfma_f32_32x32x16_bf16 v[144:159], v[236:239], v[124:127], v[144:159]
s_add_u32 m0, s52, 49152
s_add_u32 s31, s53, 49152
buffer_load_dwordx4 v192, s[16:19], s31 offen lds
v_mfma_f32_32x32x16_bf16 v[128:143], v[236:239], v[120:123], v[128:143]
ds_read_b128 v[236:239], v245 offset:16992
s_waitcnt lgkmcnt(3)
v_mfma_f32_32x32x16_bf16 v[176:191], v[224:227], v[4:7], 0
s_add_u32 m0, s52, 53248
s_add_u32 s31, s53, 49216
buffer_load_dwordx4 v192, s[16:19], s31 offen lds
v_mfma_f32_32x32x16_bf16 v[160:175], v[224:227], v[0:3], 0
ds_read_b128 v[224:227], v245 offset:17024
s_waitcnt lgkmcnt(3)
v_mfma_f32_32x32x16_bf16 v[176:191], v[228:231], v[12:15], v[176:191]
s_waitcnt vmcnt(13)
ds_read_b64_tr_b16 v[0:1], v193 offset:0
ds_read_b64_tr_b16 v[2:3], v193 offset:512
v_mfma_f32_32x32x16_bf16 v[160:175], v[228:231], v[8:11], v[160:175]
ds_read_b128 v[228:231], v245 offset:17056
s_add_u32 m0, s52, 57344
s_add_u32 s31, s53, 57344
buffer_load_dwordx4 v192, s[16:19], s31 offen lds
s_waitcnt lgkmcnt(5)
v_mfma_f32_32x32x16_bf16 v[176:191], v[232:235], v[20:23], v[176:191]
s_waitcnt vmcnt(13)
ds_read_b64_tr_b16 v[4:5], v193 offset:4096
ds_read_b64_tr_b16 v[6:7], v193 offset:4608
v_mfma_f32_32x32x16_bf16 v[160:175], v[232:235], v[16:19], v[160:175]
ds_read_b128 v[232:235], v245 offset:17088
s_add_u32 m0, s52, -92160
s_add_u32 s31, s53, 57408
buffer_load_dwordx4 v192, s[16:19], s31 offen lds
s_waitcnt lgkmcnt(7)
v_mfma_f32_32x32x16_bf16 v[176:191], v[236:239], v[28:31], v[176:191]
s_waitcnt vmcnt(13)
ds_read_b64_tr_b16 v[8:9], v193 offset:8192
ds_read_b64_tr_b16 v[10:11], v193 offset:8704
v_mfma_f32_32x32x16_bf16 v[160:175], v[236:239], v[24:27], v[160:175]
ds_read_b128 v[236:239], v245 offset:17120
s_waitcnt vmcnt(12)
ds_read_b64_tr_b16 v[12:13], v193 offset:12288
s_waitcnt lgkmcnt(10)
v_mfma_f32_32x32x16_bf16 v[176:191], v[224:227], v[36:39], v[176:191]
s_add_u32 m0, s52, -88064
s_add_u32 s31, s53, 65536
buffer_load_dwordx4 v192, s[16:19], s31 offen lds
ds_read_b64_tr_b16 v[14:15], v193 offset:12800
v_mfma_f32_32x32x16_bf16 v[160:175], v[224:227], v[32:35], v[160:175]
ds_read_b128 v[224:227], v245 offset:17152
s_waitcnt vmcnt(12)
ds_read_b64_tr_b16 v[16:17], v193 offset:16384
s_waitcnt lgkmcnt(10)
v_mfma_f32_32x32x16_bf16 v[176:191], v[228:231], v[44:47], v[176:191]
ds_read_b64_tr_b16 v[18:19], v193 offset:16896
s_waitcnt vmcnt(11)
ds_read_b64_tr_b16 v[20:21], v193 offset:20480
v_mfma_f32_32x32x16_bf16 v[160:175], v[228:231], v[40:43], v[160:175]
ds_read_b128 v[228:231], v245 offset:17184
ds_read_b64_tr_b16 v[22:23], v193 offset:20992
s_waitcnt lgkmcnt(11)
v_mfma_f32_32x32x16_bf16 v[176:191], v[232:235], v[52:55], v[176:191]
s_waitcnt vmcnt(10)
ds_read_b64_tr_b16 v[24:25], v193 offset:24576
ds_read_b64_tr_b16 v[26:27], v193 offset:25088
v_mfma_f32_32x32x16_bf16 v[160:175], v[232:235], v[48:51], v[160:175]
ds_read_b128 v[232:235], v245 offset:17216
s_waitcnt vmcnt(9)
ds_read_b64_tr_b16 v[28:29], v193 offset:28672
s_waitcnt lgkmcnt(12)
v_mfma_f32_32x32x16_bf16 v[176:191], v[236:239], v[60:63], v[176:191]
ds_read_b64_tr_b16 v[30:31], v193 offset:29184
s_waitcnt vmcnt(8)
ds_read_b64_tr_b16 v[32:33], v193 offset:32768
v_mfma_f32_32x32x16_bf16 v[160:175], v[236:239], v[56:59], v[160:175]
ds_read_b128 v[236:239], v245 offset:17248
ds_read_b64_tr_b16 v[34:35], v193 offset:33280
s_waitcnt lgkmcnt(13)
v_mfma_f32_32x32x16_bf16 v[176:191], v[224:227], v[68:71], v[176:191]
s_waitcnt vmcnt(7)
ds_read_b64_tr_b16 v[36:37], v193 offset:36864
ds_read_b64_tr_b16 v[38:39], v193 offset:37376
v_mfma_f32_32x32x16_bf16 v[160:175], v[224:227], v[64:67], v[160:175]
ds_read_b128 v[224:227], v245 offset:17280
s_waitcnt vmcnt(6)
ds_read_b64_tr_b16 v[40:41], v193 offset:40960
s_waitcnt lgkmcnt(13)
v_mfma_f32_32x32x16_bf16 v[176:191], v[228:231], v[76:79], v[176:191]
ds_read_b64_tr_b16 v[42:43], v193 offset:41472
s_waitcnt vmcnt(5)
ds_read_b64_tr_b16 v[44:45], v193 offset:45056
v_mfma_f32_32x32x16_bf16 v[160:175], v[228:231], v[72:75], v[160:175]
ds_read_b128 v[228:231], v245 offset:17312
ds_read_b64_tr_b16 v[46:47], v193 offset:45568
s_waitcnt lgkmcnt(13)
v_mfma_f32_32x32x16_bf16 v[176:191], v[232:235], v[84:87], v[176:191]
s_waitcnt vmcnt(4)
ds_read_b64_tr_b16 v[48:49], v193 offset:49152
ds_read_b64_tr_b16 v[50:51], v193 offset:49664
v_mfma_f32_32x32x16_bf16 v[160:175], v[232:235], v[80:83], v[160:175]
ds_read_b128 v[232:235], v245 offset:17344
s_waitcnt vmcnt(3)
ds_read_b64_tr_b16 v[52:53], v193 offset:53248
s_waitcnt lgkmcnt(13)
v_mfma_f32_32x32x16_bf16 v[176:191], v[236:239], v[92:95], v[176:191]
ds_read_b64_tr_b16 v[54:55], v193 offset:53760
v_mfma_f32_32x32x16_bf16 v[160:175], v[236:239], v[88:91], v[160:175]
ds_read_b128 v[236:239], v245 offset:17376
s_waitcnt vmcnt(2)
ds_read_b64_tr_b16 v[56:57], v193 offset:57344
s_waitcnt lgkmcnt(12)
v_mfma_f32_32x32x16_bf16 v[176:191], v[224:227], v[100:103], v[176:191]
ds_read_b64_tr_b16 v[58:59], v193 offset:57856
s_waitcnt vmcnt(1)
ds_read_b64_tr_b16 v[60:61], v204 offset:0
v_mfma_f32_32x32x16_bf16 v[160:175], v[224:227], v[96:99], v[160:175]
ds_read_b64_tr_b16 v[62:63], v204 offset:512
s_waitcnt lgkmcnt(11)
v_mfma_f32_32x32x16_bf16 v[176:191], v[228:231], v[108:111], v[176:191]
s_waitcnt vmcnt(0)
ds_read_b64_tr_b16 v[64:65], v204 offset:4096
ds_read_b64_tr_b16 v[66:67], v204 offset:4608
v_mfma_f32_32x32x16_bf16 v[160:175], v[228:231], v[104:107], v[160:175]
s_waitcnt lgkmcnt(9)
v_mfma_f32_32x32x16_bf16 v[176:191], v[232:235], v[116:119], v[176:191]
v_mfma_f32_32x32x16_bf16 v[160:175], v[232:235], v[112:115], v[160:175]
s_waitcnt lgkmcnt(6)
v_mfma_f32_32x32x16_bf16 v[176:191], v[236:239], v[124:127], v[176:191]
v_mfma_f32_32x32x16_bf16 v[160:175], v[236:239], v[120:123], v[160:175]
v_mov_b32 v201, 25
ds_write_b32 v199, v201
v_mul_f32 v144, s28, v144
v_mul_f32 v145, s28, v145
v_mul_f32 v146, s28, v146
v_mul_f32 v147, s28, v147
v_mul_f32 v148, s28, v148
v_mul_f32 v149, s28, v149
v_mul_f32 v150, s28, v150
v_mul_f32 v151, s28, v151
v_mul_f32 v152, s28, v152
v_mul_f32 v153, s28, v153
v_mul_f32 v154, s28, v154
v_mul_f32 v155, s28, v155
v_mul_f32 v156, s28, v156
v_mul_f32 v157, s28, v157
v_mul_f32 v158, s28, v158
v_mul_f32 v159, s28, v159
v_exp_f32 v144, v144
v_exp_f32 v145, v145
v_exp_f32 v146, v146
v_exp_f32 v147, v147
v_exp_f32 v148, v148
v_exp_f32 v149, v149
v_exp_f32 v150, v150
v_exp_f32 v151, v151
v_exp_f32 v152, v152
v_exp_f32 v153, v153
v_exp_f32 v154, v154
v_exp_f32 v155, v155
v_exp_f32 v156, v156
v_exp_f32 v157, v157
v_exp_f32 v158, v158
v_exp_f32 v159, v159
v_fma_f32 v144, v144, v240, v240
v_fma_f32 v145, v145, v240, v240
v_fma_f32 v146, v146, v240, v240
v_fma_f32 v147, v147, v240, v240
v_fma_f32 v148, v148, v240, v240
v_fma_f32 v149, v149, v240, v240
v_fma_f32 v150, v150, v240, v240
v_fma_f32 v151, v151, v240, v240
v_fma_f32 v152, v152, v240, v240
v_fma_f32 v153, v153, v240, v240
v_fma_f32 v154, v154, v240, v240
v_fma_f32 v155, v155, v240, v240
v_fma_f32 v156, v156, v240, v240
v_fma_f32 v157, v157, v240, v240
v_fma_f32 v158, v158, v240, v240
v_fma_f32 v159, v159, v240, v240
v_rcp_f32 v144, v144
v_rcp_f32 v145, v145
v_rcp_f32 v146, v146
v_rcp_f32 v147, v147
v_rcp_f32 v148, v148
v_rcp_f32 v149, v149
v_rcp_f32 v150, v150
v_rcp_f32 v151, v151
v_rcp_f32 v152, v152
v_rcp_f32 v153, v153
v_rcp_f32 v154, v154
v_rcp_f32 v155, v155
v_rcp_f32 v156, v156
v_rcp_f32 v157, v157
v_rcp_f32 v158, v158
v_rcp_f32 v159, v159
v_mul_f32 v128, v128, v144
v_mul_f32 v129, v129, v145
v_mul_f32 v130, v130, v146
v_mul_f32 v131, v131, v147
v_mul_f32 v132, v132, v148
v_mul_f32 v133, v133, v149
v_mul_f32 v134, v134, v150
v_mul_f32 v135, v135, v151
v_mul_f32 v136, v136, v152
v_mul_f32 v137, v137, v153
v_mul_f32 v138, v138, v154
v_mul_f32 v139, v139, v155
v_mul_f32 v140, v140, v156
v_mul_f32 v141, v141, v157
v_mul_f32 v202, v142, v158
v_mul_f32 v203, v143, v159
v_fma_f32 v144, v242, v128, v244
v_fma_f32 v145, v242, v129, v128
v_fma_f32 v146, v242, v130, v129
v_fma_f32 v147, v242, v131, v130
v_fma_f32 v148, v242, v132, v131
v_fma_f32 v149, v242, v133, v132
v_fma_f32 v150, v242, v134, v133
v_fma_f32 v151, v242, v135, v134
v_fma_f32 v152, v242, v136, v135
v_fma_f32 v153, v242, v137, v136
v_fma_f32 v154, v242, v138, v137
v_fma_f32 v155, v242, v139, v138
v_fma_f32 v156, v242, v140, v139
v_fma_f32 v157, v242, v141, v140
v_fma_f32 v158, v242, v202, v141
v_fma_f32 v159, v242, v203, v202
v_fmac_f32 v144, v241, v243
v_fmac_f32 v145, v241, v244
v_fmac_f32 v146, v241, v128
v_fmac_f32 v147, v241, v129
v_fmac_f32 v148, v241, v130
v_fmac_f32 v149, v241, v131
v_fmac_f32 v150, v241, v132
v_fmac_f32 v151, v241, v133
v_fmac_f32 v152, v241, v134
v_fmac_f32 v153, v241, v135
v_fmac_f32 v154, v241, v136
v_fmac_f32 v155, v241, v137
v_fmac_f32 v156, v241, v138
v_fmac_f32 v157, v241, v139
v_fmac_f32 v158, v241, v140
v_fmac_f32 v159, v241, v141
v_exp_f32 v128, v144
v_exp_f32 v129, v145
v_exp_f32 v130, v146
v_exp_f32 v131, v147
v_exp_f32 v132, v148
v_exp_f32 v133, v149
v_exp_f32 v134, v150
v_exp_f32 v135, v151
v_fma_f32 v128, v128, s28, s28
v_fma_f32 v129, v129, s28, s28
v_fma_f32 v130, v130, s28, s28
v_fma_f32 v131, v131, s28, s28
v_fma_f32 v132, v132, s28, s28
v_fma_f32 v133, v133, s28, s28
v_fma_f32 v134, v134, s28, s28
v_fma_f32 v135, v135, s28, s28
v_rcp_f32 v128, v128
v_rcp_f32 v129, v129
v_rcp_f32 v130, v130
v_rcp_f32 v131, v131
v_rcp_f32 v132, v132
v_rcp_f32 v133, v133
v_rcp_f32 v134, v134
v_rcp_f32 v135, v135
v_mul_f32 v144, v144, v128
v_mul_f32 v145, v145, v129
v_mul_f32 v146, v146, v130
v_mul_f32 v147, v147, v131
v_mul_f32 v148, v148, v132
v_mul_f32 v149, v149, v133
v_mul_f32 v150, v150, v134
v_mul_f32 v151, v151, v135
v_cvt_pk_bf16_f32 v128, v144, v145
v_cvt_pk_bf16_f32 v129, v146, v147
v_cvt_pk_bf16_f32 v130, v148, v149
v_cvt_pk_bf16_f32 v131, v150, v151
ds_write_b128 v246, v[128:131] offset:0
v_exp_f32 v136, v152
v_exp_f32 v137, v153
v_exp_f32 v138, v154
v_exp_f32 v139, v155
v_exp_f32 v140, v156
v_exp_f32 v141, v157
v_exp_f32 v142, v158
v_exp_f32 v143, v159
v_fma_f32 v136, v136, s28, s28
v_fma_f32 v137, v137, s28, s28
v_fma_f32 v138, v138, s28, s28
v_fma_f32 v139, v139, s28, s28
v_fma_f32 v140, v140, s28, s28
v_fma_f32 v141, v141, s28, s28
v_fma_f32 v142, v142, s28, s28
v_fma_f32 v143, v143, s28, s28
v_rcp_f32 v136, v136
v_rcp_f32 v137, v137
v_rcp_f32 v138, v138
v_rcp_f32 v139, v139
v_rcp_f32 v140, v140
v_rcp_f32 v141, v141
v_rcp_f32 v142, v142
v_rcp_f32 v143, v143
v_mul_f32 v152, v152, v136
v_mul_f32 v153, v153, v137
v_mul_f32 v154, v154, v138
v_mul_f32 v155, v155, v139
v_mul_f32 v156, v156, v140
v_mul_f32 v157, v157, v141
v_mul_f32 v158, v158, v142
v_mul_f32 v159, v159, v143
v_cvt_pk_bf16_f32 v136, v152, v153
v_cvt_pk_bf16_f32 v137, v154, v155
v_cvt_pk_bf16_f32 v138, v156, v157
v_cvt_pk_bf16_f32 v139, v158, v159
ds_write_b128 v247, v[136:139] offset:0
v_mul_f32 v176, s28, v176
v_mul_f32 v177, s28, v177
v_mul_f32 v178, s28, v178
v_mul_f32 v179, s28, v179
v_mul_f32 v180, s28, v180
v_mul_f32 v181, s28, v181
v_mul_f32 v182, s28, v182
v_mul_f32 v183, s28, v183
v_mul_f32 v184, s28, v184
v_mul_f32 v185, s28, v185
v_mul_f32 v186, s28, v186
v_mul_f32 v187, s28, v187
v_mul_f32 v188, s28, v188
v_mul_f32 v189, s28, v189
v_mul_f32 v190, s28, v190
v_mul_f32 v191, s28, v191
v_exp_f32 v176, v176
v_exp_f32 v177, v177
v_exp_f32 v178, v178
v_exp_f32 v179, v179
v_mov_b32 v201, 30
ds_write_b32 v199, v201
v_exp_f32 v180, v180
v_exp_f32 v181, v181
v_exp_f32 v182, v182
v_exp_f32 v183, v183
v_exp_f32 v184, v184
v_exp_f32 v185, v185
v_exp_f32 v186, v186
v_exp_f32 v187, v187
v_exp_f32 v188, v188
v_exp_f32 v189, v189
v_exp_f32 v190, v190
v_exp_f32 v191, v191
v_fma_f32 v176, v176, v240, v240
v_fma_f32 v177, v177, v240, v240
v_fma_f32 v178, v178, v240, v240
v_fma_f32 v179, v179, v240, v240
v_fma_f32 v180, v180, v240, v240
v_fma_f32 v181, v181, v240, v240
v_fma_f32 v182, v182, v240, v240
v_fma_f32 v183, v183, v240, v240
v_fma_f32 v184, v184, v240, v240
v_fma_f32 v185, v185, v240, v240
v_fma_f32 v186, v186, v240, v240
v_fma_f32 v187, v187, v240, v240
v_fma_f32 v188, v188, v240, v240
v_fma_f32 v189, v189, v240, v240
v_fma_f32 v190, v190, v240, v240
v_fma_f32 v191, v191, v240, v240
v_rcp_f32 v176, v176
v_rcp_f32 v177, v177
v_rcp_f32 v178, v178
v_rcp_f32 v179, v179
v_rcp_f32 v180, v180
v_rcp_f32 v181, v181
v_rcp_f32 v182, v182
v_rcp_f32 v183, v183
v_rcp_f32 v184, v184
v_rcp_f32 v185, v185
v_rcp_f32 v186, v186
v_rcp_f32 v187, v187
v_rcp_f32 v188, v188
v_rcp_f32 v189, v189
v_rcp_f32 v190, v190
v_rcp_f32 v191, v191
v_mul_f32 v160, v160, v176
v_mul_f32 v161, v161, v177
v_mul_f32 v162, v162, v178
v_mul_f32 v163, v163, v179
v_mul_f32 v164, v164, v180
v_mul_f32 v165, v165, v181
v_mul_f32 v166, v166, v182
v_mul_f32 v167, v167, v183
v_mul_f32 v168, v168, v184
v_mul_f32 v169, v169, v185
v_mul_f32 v170, v170, v186
v_mul_f32 v171, v171, v187
v_mul_f32 v172, v172, v188
v_mul_f32 v173, v173, v189
v_mul_f32 v243, v174, v190
v_mul_f32 v244, v175, v191
v_fma_f32 v176, v242, v160, v203
v_fma_f32 v177, v242, v161, v160
v_fma_f32 v178, v242, v162, v161
v_fma_f32 v179, v242, v163, v162
v_fma_f32 v180, v242, v164, v163
v_fma_f32 v181, v242, v165, v164
v_fma_f32 v182, v242, v166, v165
v_fma_f32 v183, v242, v167, v166
v_fma_f32 v184, v242, v168, v167
v_fma_f32 v185, v242, v169, v168
v_fma_f32 v186, v242, v170, v169
v_fma_f32 v187, v242, v171, v170
v_fma_f32 v188, v242, v172, v171
v_fma_f32 v189, v242, v173, v172
v_fma_f32 v190, v242, v243, v173
v_fma_f32 v191, v242, v244, v243
v_fmac_f32 v176, v241, v202
v_fmac_f32 v177, v241, v203
v_fmac_f32 v178, v241, v160
v_fmac_f32 v179, v241, v161
v_fmac_f32 v180, v241, v162
v_fmac_f32 v181, v241, v163
v_fmac_f32 v182, v241, v164
v_fmac_f32 v183, v241, v165
v_fmac_f32 v184, v241, v166
v_fmac_f32 v185, v241, v167
v_fmac_f32 v186, v241, v168
v_fmac_f32 v187, v241, v169
v_fmac_f32 v188, v241, v170
v_fmac_f32 v189, v241, v171
v_fmac_f32 v190, v241, v172
v_fmac_f32 v191, v241, v173
v_exp_f32 v160, v176
v_exp_f32 v161, v177
v_exp_f32 v162, v178
v_exp_f32 v163, v179
v_exp_f32 v164, v180
v_exp_f32 v165, v181
v_exp_f32 v166, v182
v_exp_f32 v167, v183
v_fma_f32 v160, v160, s28, s28
v_fma_f32 v161, v161, s28, s28
v_fma_f32 v162, v162, s28, s28
v_fma_f32 v163, v163, s28, s28
v_fma_f32 v164, v164, s28, s28
v_fma_f32 v165, v165, s28, s28
v_fma_f32 v166, v166, s28, s28
v_fma_f32 v167, v167, s28, s28
v_rcp_f32 v160, v160
v_rcp_f32 v161, v161
v_rcp_f32 v162, v162
v_rcp_f32 v163, v163
v_rcp_f32 v164, v164
v_rcp_f32 v165, v165
v_rcp_f32 v166, v166
v_rcp_f32 v167, v167
v_mul_f32 v176, v176, v160
v_mul_f32 v177, v177, v161
v_mul_f32 v178, v178, v162
v_mul_f32 v179, v179, v163
v_mul_f32 v180, v180, v164
v_mul_f32 v181, v181, v165
v_mul_f32 v182, v182, v166
v_mul_f32 v183, v183, v167
v_cvt_pk_bf16_f32 v160, v176, v177
v_cvt_pk_bf16_f32 v161, v178, v179
v_cvt_pk_bf16_f32 v162, v180, v181
v_cvt_pk_bf16_f32 v163, v182, v183
ds_write_b128 v246, v[160:163] offset:16896
v_exp_f32 v168, v184
v_exp_f32 v169, v185
v_exp_f32 v170, v186
v_exp_f32 v171, v187
v_exp_f32 v172, v188
v_exp_f32 v173, v189
v_exp_f32 v174, v190
v_exp_f32 v175, v191
v_fma_f32 v168, v168, s28, s28
v_fma_f32 v169, v169, s28, s28
v_fma_f32 v170, v170, s28, s28
v_fma_f32 v171, v171, s28, s28
v_fma_f32 v172, v172, s28, s28
v_fma_f32 v173, v173, s28, s28
v_fma_f32 v174, v174, s28, s28
v_fma_f32 v175, v175, s28, s28
v_rcp_f32 v168, v168
v_rcp_f32 v169, v169
v_rcp_f32 v170, v170
v_rcp_f32 v171, v171
v_rcp_f32 v172, v172
v_rcp_f32 v173, v173
ds_read_b32 v200, v198
v_rcp_f32 v174, v174
v_rcp_f32 v175, v175
v_mul_f32 v184, v184, v168
v_mul_f32 v185, v185, v169
v_mul_f32 v186, v186, v170
v_mul_f32 v187, v187, v171
v_mul_f32 v188, v188, v172
v_mul_f32 v189, v189, v173
v_mul_f32 v190, v190, v174
v_mul_f32 v191, v191, v175
v_cvt_pk_bf16_f32 v168, v184, v185
v_cvt_pk_bf16_f32 v169, v186, v187
v_cvt_pk_bf16_f32 v170, v188, v189
v_cvt_pk_bf16_f32 v171, v190, v191
ds_write_b128 v247, v[168:171] offset:16896
s_waitcnt lgkmcnt(1)
v_cmp_gt_u32 vcc, 30, v200
s_cbranch_vccnz L_waitP30
L_goP30:
ds_read_b64_tr_b16 v[208:209], v248 offset:33792
ds_read_b64_tr_b16 v[210:211], v248 offset:34304
ds_read_b64_tr_b16 v[212:213], v248 offset:34816
ds_read_b64_tr_b16 v[214:215], v248 offset:35328
ds_read_b64_tr_b16 v[216:217], v248 offset:35840
ds_read_b64_tr_b16 v[218:219], v248 offset:36352
ds_read_b64_tr_b16 v[220:221], v248 offset:36864
ds_read_b64_tr_b16 v[222:223], v248 offset:37376
s_waitcnt lgkmcnt(6)
v_mfma_f32_32x32x16_bf16 v[128:143], v[0:3], v[208:211], 0
ds_read_b64_tr_b16 v[68:69], v193 offset:0
ds_read_b64_tr_b16 v[70:71], v193 offset:512
v_mov_b32 v201, 60
ds_write_b32 v199, v201
v_mfma_f32_32x32x16_bf16 v[144:159], v[4:7], v[208:211], 0
ds_read_b64_tr_b16 v[208:209], v248 offset:37888
s_waitcnt lgkmcnt(8)
v_mfma_f32_32x32x16_bf16 v[128:143], v[8:11], v[212:215], v[128:143]
ds_read_b64_tr_b16 v[210:211], v248 offset:38400
ds_read_b64_tr_b16 v[72:73], v193 offset:4096
v_mfma_f32_32x32x16_bf16 v[144:159], v[12:15], v[212:215], v[144:159]
ds_read_b64_tr_b16 v[212:213], v248 offset:38912
ds_read_b64_tr_b16 v[74:75], v193 offset:4608
s_waitcnt lgkmcnt(10)
v_mfma_f32_32x32x16_bf16 v[128:143], v[16:19], v[216:219], v[128:143]
ds_read_b64_tr_b16 v[214:215], v248 offset:39424
ds_read_b64_tr_b16 v[76:77], v193 offset:8192
v_mfma_f32_32x32x16_bf16 v[144:159], v[20:23], v[216:219], v[144:159]
ds_read_b64_tr_b16 v[216:217], v248 offset:39936
ds_read_b64_tr_b16 v[78:79], v193 offset:8704
s_waitcnt lgkmcnt(12)
v_mfma_f32_32x32x16_bf16 v[128:143], v[24:27], v[220:223], v[128:143]
ds_read_b64_tr_b16 v[218:219], v248 offset:40448
ds_read_b64_tr_b16 v[80:81], v193 offset:12288
v_mfma_f32_32x32x16_bf16 v[144:159], v[28:31], v[220:223], v[144:159]
ds_read_b64_tr_b16 v[220:221], v248 offset:40960
ds_read_b64_tr_b16 v[82:83], v193 offset:12800
s_waitcnt lgkmcnt(11)
v_mfma_f32_32x32x16_bf16 v[128:143], v[32:35], v[208:211], v[128:143]
ds_read_b64_tr_b16 v[222:223], v248 offset:41472
ds_read_b64_tr_b16 v[84:85], v193 offset:16384
v_mfma_f32_32x32x16_bf16 v[144:159], v[36:39], v[208:211], v[144:159]
ds_read_b64_tr_b16 v[208:209], v248 offset:41984
ds_read_b64_tr_b16 v[86:87], v193 offset:16896
s_waitcnt lgkmcnt(11)
v_mfma_f32_32x32x16_bf16 v[128:143], v[40:43], v[212:215], v[128:143]
ds_read_b64_tr_b16 v[210:211], v248 offset:42496
ds_read_b64_tr_b16 v[88:89], v193 offset:20480
v_mfma_f32_32x32x16_bf16 v[144:159], v[44:47], v[212:215], v[144:159]
ds_read_b64_tr_b16 v[212:213], v248 offset:43008
ds_read_b64_tr_b16 v[90:91], v193 offset:20992
s_waitcnt lgkmcnt(11)
v_mfma_f32_32x32x16_bf16 v[128:143], v[48:51], v[216:219], v[128:143]
ds_read_b64_tr_b16 v[214:215], v248 offset:43520
ds_read_b64_tr_b16 v[92:93], v193 offset:24576
v_mfma_f32_32x32x16_bf16 v[144:159], v[52:55], v[216:219], v[144:159]
ds_read_b64_tr_b16 v[216:217], v248 offset:44032
ds_read_b64_tr_b16 v[94:95], v193 offset:25088
s_waitcnt lgkmcnt(11)
v_mfma_f32_32x32x16_bf16 v[128:143], v[56:59], v[220:223], v[128:143]
ds_read_b64_tr_b16 v[218:219], v248 offset:44544
ds_read_b64_tr_b16 v[96:97], v193 offset:28672
v_mfma_f32_32x32x16_bf16 v[144:159], v[60:63], v[220:223], v[144:159]
ds_read_b64_tr_b16 v[220:221], v248 offset:45056
ds_read_b64_tr_b16 v[98:99], v193 offset:29184
s_waitcnt lgkmcnt(11)
v_mfma_f32_32x32x16_bf16 v[128:143], v[64:67], v[208:211], v[128:143]
ds_read_b64_tr_b16 v[222:223], v248 offset:45568
ds_read_b64_tr_b16 v[100:101], v193 offset:32768
v_mfma_f32_32x32x16_bf16 v[144:159], v[68:71], v[208:211], v[144:159]
ds_read_b64_tr_b16 v[208:209], v248 offset:46080
ds_read_b64_tr_b16 v[102:103], v193 offset:33280
s_waitcnt lgkmcnt(11)
v_mfma_f32_32x32x16_bf16 v[128:143], v[72:75], v[212:215], v[128:143]
ds_read_b64_tr_b16 v[210:211], v248 offset:46592
ds_read_b64_tr_b16 v[104:105], v193 offset:36864
v_mfma_f32_32x32x16_bf16 v[144:159], v[76:79], v[212:215], v[144:159]
ds_read_b64_tr_b16 v[212:213], v248 offset:47104
ds_read_b64_tr_b16 v[106:107], v193 offset:37376
s_waitcnt lgkmcnt(11)
v_mfma_f32_32x32x16_bf16 v[128:143], v[80:83], v[216:219], v[128:143]
ds_read_b64_tr_b16 v[214:215], v248 offset:47616
ds_read_b64_tr_b16 v[108:109], v193 offset:40960
v_mfma_f32_32x32x16_bf16 v[144:159], v[84:87], v[216:219], v[144:159]
ds_read_b64_tr_b16 v[216:217], v248 offset:48128
ds_read_b64_tr_b16 v[110:111], v193 offset:41472
s_waitcnt lgkmcnt(11)
v_mfma_f32_32x32x16_bf16 v[128:143], v[88:91], v[220:223], v[128:143]
ds_read_b64_tr_b16 v[218:219], v248 offset:48640
ds_read_b64_tr_b16 v[112:113], v193 offset:45056
v_mfma_f32_32x32x16_bf16 v[144:159], v[92:95], v[220:223], v[144:159]
ds_read_b64_tr_b16 v[220:221], v248 offset:49152
ds_read_b64_tr_b16 v[114:115], v193 offset:45568
s_waitcnt lgkmcnt(11)
v_mfma_f32_32x32x16_bf16 v[128:143], v[96:99], v[208:211], v[128:143]
ds_read_b64_tr_b16 v[222:223], v248 offset:49664
ds_read_b64_tr_b16 v[116:117], v193 offset:49152
v_mfma_f32_32x32x16_bf16 v[144:159], v[100:103], v[208:211], v[144:159]
v_add_u32 v248, 33792, v248
ds_read_b64_tr_b16 v[208:209], v248 offset:16384
ds_read_b64_tr_b16 v[118:119], v193 offset:49664
s_waitcnt lgkmcnt(8)
v_mfma_f32_32x32x16_bf16 v[128:143], v[104:107], v[212:215], v[128:143]
ds_read_b64_tr_b16 v[210:211], v248 offset:16896
ds_read_b64_tr_b16 v[120:121], v193 offset:53248
v_mfma_f32_32x32x16_bf16 v[144:159], v[108:111], v[212:215], v[144:159]
ds_read_b64_tr_b16 v[212:213], v248 offset:17408
ds_read_b64_tr_b16 v[122:123], v193 offset:53760
s_waitcnt lgkmcnt(4)
v_mfma_f32_32x32x16_bf16 v[128:143], v[112:115], v[216:219], v[128:143]
ds_read_b64_tr_b16 v[214:215], v248 offset:17920
ds_read_b64_tr_b16 v[124:125], v193 offset:57344
v_mfma_f32_32x32x16_bf16 v[144:159], v[116:119], v[216:219], v[144:159]
ds_read_b64_tr_b16 v[216:217], v248 offset:18432
ds_read_b64_tr_b16 v[126:127], v193 offset:57856
s_waitcnt lgkmcnt(0)
v_mfma_f32_32x32x16_bf16 v[128:143], v[120:123], v[220:223], v[128:143]
ds_read_b64_tr_b16 v[218:219], v248 offset:18944
v_mfma_f32_32x32x16_bf16 v[144:159], v[124:127], v[220:223], v[144:159]
ds_read_b64_tr_b16 v[220:221], v248 offset:19456
v_mfma_f32_32x32x16_bf16 v[160:175], v[0:3], v[208:211], 0
ds_read_b64_tr_b16 v[222:223], v248 offset:19968
v_mfma_f32_32x32x16_bf16 v[176:191], v[4:7], v[208:211], 0
ds_read_b64_tr_b16 v[208:209], v248 offset:20480
v_mfma_f32_32x32x16_bf16 v[160:175], v[8:11], v[212:215], v[160:175]
ds_read_b64_tr_b16 v[210:211], v248 offset:20992
v_mfma_f32_32x32x16_bf16 v[176:191], v[12:15], v[212:215], v[176:191]
ds_read_b64_tr_b16 v[212:213], v248 offset:21504
s_waitcnt lgkmcnt(5)
v_mfma_f32_32x32x16_bf16 v[160:175], v[16:19], v[216:219], v[160:175]
ds_read_b64_tr_b16 v[214:215], v248 offset:22016
v_cvt_pk_bf16_f32 v128, v128, v129
v_cvt_pk_bf16_f32 v129, v130, v131
v_cvt_pk_bf16_f32 v130, v132, v133
v_cvt_pk_bf16_f32 v131, v134, v135
v_mfma_f32_32x32x16_bf16 v[176:191], v[20:23], v[216:219], v[176:191]
ds_read_b32 v200, v198
ds_write_b128 v194, v[128:131] offset:0
v_cvt_pk_bf16_f32 v136, v136, v137
s_waitcnt lgkmcnt(6)
v_mfma_f32_32x32x16_bf16 v[160:175], v[24:27], v[220:223], v[160:175]
ds_read_b64_tr_b16 v[216:217], v248 offset:22528
v_cvt_pk_bf16_f32 v137, v138, v139
v_cvt_pk_bf16_f32 v138, v140, v141
v_cvt_pk_bf16_f32 v139, v142, v143
v_mfma_f32_32x32x16_bf16 v[176:191], v[28:31], v[220:223], v[176:191]
ds_read_b64_tr_b16 v[218:219], v248 offset:23040
ds_write_b128 v194, v[136:139] offset:32
s_waitcnt lgkmcnt(7)
v_mfma_f32_32x32x16_bf16 v[160:175], v[32:35], v[208:211], v[160:175]
ds_read_b64_tr_b16 v[220:221], v248 offset:23552
v_cvt_pk_bf16_f32 v144, v144, v145
v_cvt_pk_bf16_f32 v145, v146, v147
v_cvt_pk_bf16_f32 v146, v148, v149
v_cvt_pk_bf16_f32 v147, v150, v151
v_mfma_f32_32x32x16_bf16 v[176:191], v[36:39], v[208:211], v[176:191]
ds_read_b64_tr_b16 v[222:223], v248 offset:24064
ds_write_b128 v194, v[144:147] offset:64
s_waitcnt lgkmcnt(8)
v_mfma_f32_32x32x16_bf16 v[160:175], v[40:43], v[212:215], v[160:175]
s_waitcnt lgkmcnt(7)
v_cmp_gt_u32 vcc, 35, v200
s_cbranch_vccnz L_waitP35
L_goP35:
v_cvt_pk_bf16_f32 v152, v152, v153
v_cvt_pk_bf16_f32 v153, v154, v155
v_cvt_pk_bf16_f32 v154, v156, v157
v_cvt_pk_bf16_f32 v155, v158, v159
v_mfma_f32_32x32x16_bf16 v[176:191], v[44:47], v[212:215], v[176:191]
ds_read_b64_tr_b16 v[208:209], v248 offset:24576
ds_write_b128 v194, v[152:155] offset:96
s_waitcnt lgkmcnt(6)
v_mfma_f32_32x32x16_bf16 v[160:175], v[48:51], v[216:219], v[160:175]
ds_read_b64_tr_b16 v[210:211], v248 offset:25088
ds_read_b128 v[132:135], v195 offset:0
v_mfma_f32_32x32x16_bf16 v[176:191], v[52:55], v[216:219], v[176:191]
ds_read_b64_tr_b16 v[212:213], v248 offset:25600
ds_read_b128 v[140:143], v195 offset:1152
s_waitcnt lgkmcnt(7)
v_mfma_f32_32x32x16_bf16 v[160:175], v[56:59], v[220:223], v[160:175]
ds_read_b64_tr_b16 v[214:215], v248 offset:26112
ds_read_b128 v[148:151], v195 offset:2304
v_mfma_f32_32x32x16_bf16 v[176:191], v[60:63], v[220:223], v[176:191]
ds_read_b64_tr_b16 v[216:217], v248 offset:26624
ds_read_b128 v[156:159], v195 offset:3456
s_waitcnt lgkmcnt(7)
v_mfma_f32_32x32x16_bf16 v[160:175], v[64:67], v[208:211], v[160:175]
ds_read_b64_tr_b16 v[218:219], v248 offset:27136
s_mov_b32 s31, 28672
s_waitcnt lgkmcnt(7)
s_mov_b32 exec_lo, 0xffffff00
buffer_store_dwordx4 v[132:135], v197, s[20:23], s31 offen sc1 nt
s_mov_b64 exec, -1
v_mfma_f32_32x32x16_bf16 v[176:191], v[68:71], v[208:211], v[176:191]
ds_read_b64_tr_b16 v[220:221], v248 offset:27648
ds_read_b64_tr_b16 v[222:223], v248 offset:28160
s_waitcnt lgkmcnt(6)
v_mfma_f32_32x32x16_bf16 v[160:175], v[72:75], v[212:215], v[160:175]
ds_read_b64_tr_b16 v[208:209], v248 offset:28672
s_mov_b32 s31, 24576
buffer_store_dwordx4 v[140:143], v197, s[20:23], s31 offen sc1 nt
v_mfma_f32_32x32x16_bf16 v[176:191], v[76:79], v[212:215], v[176:191]
ds_read_b64_tr_b16 v[210:211], v248 offset:29184
ds_read_b64_tr_b16 v[212:213], v248 offset:29696
s_waitcnt lgkmcnt(5)
v_mfma_f32_32x32x16_bf16 v[160:175], v[80:83], v[216:219], v[160:175]
ds_read_b64_tr_b16 v[214:215], v248 offset:30208
v_mfma_f32_32x32x16_bf16 v[176:191], v[84:87], v[216:219], v[176:191]
ds_read_b64_tr_b16 v[216:217], v248 offset:30720
s_waitcnt lgkmcnt(5)
v_mfma_f32_32x32x16_bf16 v[160:175], v[88:91], v[220:223], v[160:175]
ds_read_b64_tr_b16 v[218:219], v248 offset:31232
v_mfma_f32_32x32x16_bf16 v[176:191], v[92:95], v[220:223], v[176:191]
ds_read_b64_tr_b16 v[220:221], v248 offset:31744
s_waitcnt lgkmcnt(5)
v_mfma_f32_32x32x16_bf16 v[160:175], v[96:99], v[208:211], v[160:175]
ds_read_b64_tr_b16 v[222:223], v248 offset:32256
s_mov_b32 s31, 0
s_mov_b32 exec_lo, 0xffffff00
buffer_store_dwordx4 v[148:151], v196, s[20:23], s31 offen sc1 nt
s_mov_b64 exec, -1
v_mfma_f32_32x32x16_bf16 v[176:191], v[100:103], v[208:211], v[176:191]
v_add_u32 v248, -33792, v248
ds_read_b64_tr_b16 v[208:209], v248 offset:0
s_waitcnt lgkmcnt(5)
v_mfma_f32_32x32x16_bf16 v[160:175], v[104:107], v[212:215], v[160:175]
ds_read_b64_tr_b16 v[210:211], v248 offset:512
v_mfma_f32_32x32x16_bf16 v[176:191], v[108:111], v[212:215], v[176:191]
ds_read_b64_tr_b16 v[212:213], v248 offset:1024
s_waitcnt lgkmcnt(5)
v_mfma_f32_32x32x16_bf16 v[160:175], v[112:115], v[216:219], v[160:175]
ds_read_b64_tr_b16 v[214:215], v248 offset:1536
v_mfma_f32_32x32x16_bf16 v[176:191], v[116:119], v[216:219], v[176:191]
ds_read_b64_tr_b16 v[216:217], v248 offset:2048
s_waitcnt lgkmcnt(5)
v_mfma_f32_32x32x16_bf16 v[160:175], v[120:123], v[220:223], v[160:175]
ds_read_b64_tr_b16 v[218:219], v248 offset:2560
s_mov_b32 s31, 4096
buffer_store_dwordx4 v[156:159], v196, s[20:23], s31 offen sc1 nt
v_mfma_f32_32x32x16_bf16 v[176:191], v[124:127], v[220:223], v[176:191]
ds_read_b64_tr_b16 v[220:221], v248 offset:3072
s_waitcnt lgkmcnt(5)
v_mfma_f32_32x32x16_bf16 v[128:143], v[0:3], v[208:211], 0
ds_read_b64_tr_b16 v[222:223], v248 offset:3584
v_mfma_f32_32x32x16_bf16 v[144:159], v[4:7], v[208:211], 0
ds_read_b64_tr_b16 v[208:209], v248 offset:4096
s_waitcnt lgkmcnt(5)
v_mfma_f32_32x32x16_bf16 v[128:143], v[8:11], v[212:215], v[128:143]
ds_read_b64_tr_b16 v[210:211], v248 offset:4608
v_mfma_f32_32x32x16_bf16 v[144:159], v[12:15], v[212:215], v[144:159]
ds_read_b64_tr_b16 v[212:213], v248 offset:5120
s_waitcnt lgkmcnt(5)
v_mfma_f32_32x32x16_bf16 v[128:143], v[16:19], v[216:219], v[128:143]
ds_read_b64_tr_b16 v[214:215], v248 offset:5632
v_cvt_pk_bf16_f32 v160, v160, v161
v_cvt_pk_bf16_f32 v161, v162, v163
v_cvt_pk_bf16_f32 v162, v164, v165
v_cvt_pk_bf16_f32 v163, v166, v167
v_mfma_f32_32x32x16_bf16 v[144:159], v[20:23], v[216:219], v[144:159]
ds_read_b32 v200, v198
ds_write_b128 v194, v[160:163] offset:0
v_cvt_pk_bf16_f32 v168, v168, v169
s_waitcnt lgkmcnt(6)
v_mfma_f32_32x32x16_bf16 v[128:143], v[24:27], v[220:223], v[128:143]
ds_read_b64_tr_b16 v[216:217], v248 offset:6144
v_cvt_pk_bf16_f32 v169, v170, v171
v_cvt_pk_bf16_f32 v170, v172, v173
v_cvt_pk_bf16_f32 v171, v174, v175
v_mfma_f32_32x32x16_bf16 v[144:159], v[28:31], v[220:223], v[144:159]
ds_read_b64_tr_b16 v[218:219], v248 offset:6656
ds_write_b128 v194, v[168:171] offset:32
s_waitcnt lgkmcnt(7)
v_mfma_f32_32x32x16_bf16 v[128:143], v[32:35], v[208:211], v[128:143]
ds_read_b64_tr_b16 v[220:221], v248 offset:7168
v_cvt_pk_bf16_f32 v176, v176, v177
v_cvt_pk_bf16_f32 v177, v178, v179
v_cvt_pk_bf16_f32 v178, v180, v181
v_cvt_pk_bf16_f32 v179, v182, v183
v_mfma_f32_32x32x16_bf16 v[144:159], v[36:39], v[208:211], v[144:159]
ds_read_b64_tr_b16 v[222:223], v248 offset:7680
ds_write_b128 v194, v[176:179] offset:64
s_waitcnt lgkmcnt(8)
v_mfma_f32_32x32x16_bf16 v[128:143], v[40:43], v[212:215], v[128:143]
s_waitcnt lgkmcnt(7)
v_cmp_gt_u32 vcc, 40, v200
s_cbranch_vccnz L_waitP40
L_goP40:
v_cvt_pk_bf16_f32 v184, v184, v185
v_cvt_pk_bf16_f32 v185, v186, v187
v_cvt_pk_bf16_f32 v186, v188, v189
v_cvt_pk_bf16_f32 v187, v190, v191
v_mfma_f32_32x32x16_bf16 v[144:159], v[44:47], v[212:215], v[144:159]
ds_read_b64_tr_b16 v[208:209], v248 offset:8192
ds_write_b128 v194, v[184:187] offset:96
s_waitcnt lgkmcnt(6)
v_mfma_f32_32x32x16_bf16 v[128:143], v[48:51], v[216:219], v[128:143]
ds_read_b64_tr_b16 v[210:211], v248 offset:8704
ds_read_b128 v[164:167], v195 offset:0
v_mfma_f32_32x32x16_bf16 v[144:159], v[52:55], v[216:219], v[144:159]
ds_read_b64_tr_b16 v[212:213], v248 offset:9216
ds_read_b128 v[172:175], v195 offset:1152
s_waitcnt lgkmcnt(7)
v_mfma_f32_32x32x16_bf16 v[128:143], v[56:59], v[220:223], v[128:143]
ds_read_b64_tr_b16 v[214:215], v248 offset:9728
ds_read_b128 v[180:183], v195 offset:2304
v_mfma_f32_32x32x16_bf16 v[144:159], v[60:63], v[220:223], v[144:159]
ds_read_b64_tr_b16 v[216:217], v248 offset:10240
ds_read_b128 v[188:191], v195 offset:3456
s_waitcnt lgkmcnt(7)
v_mfma_f32_32x32x16_bf16 v[128:143], v[64:67], v[208:211], v[128:143]
ds_read_b64_tr_b16 v[218:219], v248 offset:10752
s_mov_b32 s31, 20480
s_waitcnt lgkmcnt(7)
buffer_store_dwordx4 v[164:167], v197, s[20:23], s31 offen sc1 nt
v_mfma_f32_32x32x16_bf16 v[144:159], v[68:71], v[208:211], v[144:159]
ds_read_b64_tr_b16 v[220:221], v248 offset:11264
ds_read_b64_tr_b16 v[222:223], v248 offset:11776
s_waitcnt lgkmcnt(6)
v_mfma_f32_32x32x16_bf16 v[128:143], v[72:75], v[212:215], v[128:143]
ds_read_b64_tr_b16 v[208:209], v248 offset:12288
s_mov_b32 s31, 16384
buffer_store_dwordx4 v[172:175], v197, s[20:23], s31 offen sc1 nt
v_mfma_f32_32x32x16_bf16 v[144:159], v[76:79], v[212:215], v[144:159]
ds_read_b64_tr_b16 v[210:211], v248 offset:12800
ds_read_b64_tr_b16 v[212:213], v248 offset:13312
s_waitcnt lgkmcnt(5)
v_mfma_f32_32x32x16_bf16 v[128:143], v[80:83], v[216:219], v[128:143]
ds_read_b64_tr_b16 v[214:215], v248 offset:13824
v_mfma_f32_32x32x16_bf16 v[144:159], v[84:87], v[216:219], v[144:159]
ds_read_b64_tr_b16 v[216:217], v248 offset:14336
s_waitcnt lgkmcnt(5)
v_mfma_f32_32x32x16_bf16 v[128:143], v[88:91], v[220:223], v[128:143]
ds_read_b64_tr_b16 v[218:219], v248 offset:14848
v_mfma_f32_32x32x16_bf16 v[144:159], v[92:95], v[220:223], v[144:159]
ds_read_b64_tr_b16 v[220:221], v248 offset:15360
s_waitcnt lgkmcnt(5)
v_mfma_f32_32x32x16_bf16 v[128:143], v[96:99], v[208:211], v[128:143]
ds_read_b64_tr_b16 v[222:223], v248 offset:15872
s_mov_b32 s31, 8192
buffer_store_dwordx4 v[180:183], v196, s[20:23], s31 offen sc1 nt
v_mfma_f32_32x32x16_bf16 v[144:159], v[100:103], v[208:211], v[144:159]
ds_read_b64_tr_b16 v[208:209], v248 offset:16896
s_waitcnt lgkmcnt(5)
v_mfma_f32_32x32x16_bf16 v[128:143], v[104:107], v[212:215], v[128:143]
ds_read_b64_tr_b16 v[210:211], v248 offset:17408
v_mfma_f32_32x32x16_bf16 v[144:159], v[108:111], v[212:215], v[144:159]
ds_read_b64_tr_b16 v[212:213], v248 offset:17920
s_waitcnt lgkmcnt(5)
v_mfma_f32_32x32x16_bf16 v[128:143], v[112:115], v[216:219], v[128:143]
ds_read_b64_tr_b16 v[214:215], v248 offset:18432
v_mfma_f32_32x32x16_bf16 v[144:159], v[116:119], v[216:219], v[144:159]
ds_read_b64_tr_b16 v[216:217], v248 offset:18944
s_waitcnt lgkmcnt(5)
v_mfma_f32_32x32x16_bf16 v[128:143], v[120:123], v[220:223], v[128:143]
ds_read_b64_tr_b16 v[218:219], v248 offset:19456
s_mov_b32 s31, 12288
buffer_store_dwordx4 v[188:191], v196, s[20:23], s31 offen sc1 nt
v_mfma_f32_32x32x16_bf16 v[144:159], v[124:127], v[220:223], v[144:159]
ds_read_b64_tr_b16 v[220:221], v248 offset:19968
s_waitcnt lgkmcnt(5)
v_mfma_f32_32x32x16_bf16 v[160:175], v[0:3], v[208:211], 0
ds_read_b64_tr_b16 v[222:223], v248 offset:20480
v_mfma_f32_32x32x16_bf16 v[176:191], v[4:7], v[208:211], 0
ds_read_b64_tr_b16 v[208:209], v248 offset:20992
s_waitcnt lgkmcnt(5)
v_mfma_f32_32x32x16_bf16 v[160:175], v[8:11], v[212:215], v[160:175]
ds_read_b64_tr_b16 v[210:211], v248 offset:21504
v_mfma_f32_32x32x16_bf16 v[176:191], v[12:15], v[212:215], v[176:191]
ds_read_b64_tr_b16 v[212:213], v248 offset:22016
s_waitcnt lgkmcnt(5)
v_mfma_f32_32x32x16_bf16 v[160:175], v[16:19], v[216:219], v[160:175]
ds_read_b64_tr_b16 v[214:215], v248 offset:22528
v_cvt_pk_bf16_f32 v128, v128, v129
v_cvt_pk_bf16_f32 v129, v130, v131
v_cvt_pk_bf16_f32 v130, v132, v133
v_cvt_pk_bf16_f32 v131, v134, v135
v_mfma_f32_32x32x16_bf16 v[176:191], v[20:23], v[216:219], v[176:191]
ds_read_b32 v200, v198
ds_write_b128 v194, v[128:131] offset:0
v_cvt_pk_bf16_f32 v136, v136, v137
s_waitcnt lgkmcnt(6)
v_mfma_f32_32x32x16_bf16 v[160:175], v[24:27], v[220:223], v[160:175]
ds_read_b64_tr_b16 v[216:217], v248 offset:23040
v_cvt_pk_bf16_f32 v137, v138, v139
v_cvt_pk_bf16_f32 v138, v140, v141
v_cvt_pk_bf16_f32 v139, v142, v143
v_mfma_f32_32x32x16_bf16 v[176:191], v[28:31], v[220:223], v[176:191]
ds_read_b64_tr_b16 v[218:219], v248 offset:23552
ds_write_b128 v194, v[136:139] offset:32
s_waitcnt lgkmcnt(7)
v_mfma_f32_32x32x16_bf16 v[160:175], v[32:35], v[208:211], v[160:175]
ds_read_b64_tr_b16 v[220:221], v248 offset:24064
v_cvt_pk_bf16_f32 v144, v144, v145
v_cvt_pk_bf16_f32 v145, v146, v147
v_cvt_pk_bf16_f32 v146, v148, v149
v_cvt_pk_bf16_f32 v147, v150, v151
v_mfma_f32_32x32x16_bf16 v[176:191], v[36:39], v[208:211], v[176:191]
ds_read_b64_tr_b16 v[222:223], v248 offset:24576
ds_write_b128 v194, v[144:147] offset:64
s_waitcnt lgkmcnt(8)
v_mfma_f32_32x32x16_bf16 v[160:175], v[40:43], v[212:215], v[160:175]
s_waitcnt lgkmcnt(7)
v_cmp_gt_u32 vcc, 50, v200
s_cbranch_vccnz L_waitP50
L_goP50:
v_cvt_pk_bf16_f32 v152, v152, v153
v_cvt_pk_bf16_f32 v153, v154, v155
v_cvt_pk_bf16_f32 v154, v156, v157
v_cvt_pk_bf16_f32 v155, v158, v159
v_mfma_f32_32x32x16_bf16 v[176:191], v[44:47], v[212:215], v[176:191]
ds_read_b64_tr_b16 v[208:209], v248 offset:25088
ds_write_b128 v194, v[152:155] offset:96
s_waitcnt lgkmcnt(6)
v_mfma_f32_32x32x16_bf16 v[160:175], v[48:51], v[216:219], v[160:175]
ds_read_b64_tr_b16 v[210:211], v248 offset:25600
ds_read_b128 v[132:135], v195 offset:0
v_mfma_f32_32x32x16_bf16 v[176:191], v[52:55], v[216:219], v[176:191]
ds_read_b64_tr_b16 v[212:213], v248 offset:26112
ds_read_b128 v[140:143], v195 offset:1152
s_waitcnt lgkmcnt(7)
v_mfma_f32_32x32x16_bf16 v[160:175], v[56:59], v[220:223], v[160:175]
ds_read_b64_tr_b16 v[214:215], v248 offset:26624
ds_read_b128 v[148:151], v195 offset:2304
v_mfma_f32_32x32x16_bf16 v[176:191], v[60:63], v[220:223], v[176:191]
ds_read_b64_tr_b16 v[216:217], v248 offset:27136
ds_read_b128 v[156:159], v195 offset:3456
s_waitcnt lgkmcnt(7)
v_mfma_f32_32x32x16_bf16 v[160:175], v[64:67], v[208:211], v[160:175]
ds_read_b64_tr_b16 v[218:219], v248 offset:27648
s_mov_b32 s31, 12288
s_waitcnt lgkmcnt(7)
buffer_store_dwordx4 v[132:135], v197, s[20:23], s31 offen sc1 nt
v_mfma_f32_32x32x16_bf16 v[176:191], v[68:71], v[208:211], v[176:191]
ds_read_b64_tr_b16 v[220:221], v248 offset:28160
ds_read_b64_tr_b16 v[222:223], v248 offset:28672
s_waitcnt lgkmcnt(6)
v_mfma_f32_32x32x16_bf16 v[160:175], v[72:75], v[212:215], v[160:175]
ds_read_b64_tr_b16 v[208:209], v248 offset:29184
s_mov_b32 s31, 8192
buffer_store_dwordx4 v[140:143], v197, s[20:23], s31 offen sc1 nt
v_mfma_f32_32x32x16_bf16 v[176:191], v[76:79], v[212:215], v[176:191]
ds_read_b64_tr_b16 v[210:211], v248 offset:29696
ds_read_b64_tr_b16 v[212:213], v248 offset:30208
s_waitcnt lgkmcnt(5)
v_mfma_f32_32x32x16_bf16 v[160:175], v[80:83], v[216:219], v[160:175]
ds_read_b64_tr_b16 v[214:215], v248 offset:30720
v_mfma_f32_32x32x16_bf16 v[176:191], v[84:87], v[216:219], v[176:191]
ds_read_b64_tr_b16 v[216:217], v248 offset:31232
s_waitcnt lgkmcnt(5)
v_mfma_f32_32x32x16_bf16 v[160:175], v[88:91], v[220:223], v[160:175]
ds_read_b64_tr_b16 v[218:219], v248 offset:31744
v_mfma_f32_32x32x16_bf16 v[176:191], v[92:95], v[220:223], v[176:191]
ds_read_b64_tr_b16 v[220:221], v248 offset:32256
s_waitcnt lgkmcnt(5)
v_mfma_f32_32x32x16_bf16 v[160:175], v[96:99], v[208:211], v[160:175]
ds_read_b64_tr_b16 v[222:223], v248 offset:32768
s_mov_b32 s31, 16384
buffer_store_dwordx4 v[148:151], v196, s[20:23], s31 offen sc1 nt
v_mfma_f32_32x32x16_bf16 v[176:191], v[100:103], v[208:211], v[176:191]
s_waitcnt lgkmcnt(4)
v_mfma_f32_32x32x16_bf16 v[160:175], v[104:107], v[212:215], v[160:175]
v_mfma_f32_32x32x16_bf16 v[176:191], v[108:111], v[212:215], v[176:191]
s_waitcnt lgkmcnt(2)
v_mfma_f32_32x32x16_bf16 v[160:175], v[112:115], v[216:219], v[160:175]
v_mfma_f32_32x32x16_bf16 v[176:191], v[116:119], v[216:219], v[176:191]
s_waitcnt lgkmcnt(0)
v_mfma_f32_32x32x16_bf16 v[160:175], v[120:123], v[220:223], v[160:175]
s_mov_b32 s31, 20480
buffer_store_dwordx4 v[156:159], v196, s[20:23], s31 offen sc1 nt
v_mfma_f32_32x32x16_bf16 v[176:191], v[124:127], v[220:223], v[176:191]
s_nop 10
v_cvt_pk_bf16_f32 v160, v160, v161
v_cvt_pk_bf16_f32 v161, v162, v163
v_cvt_pk_bf16_f32 v162, v164, v165
v_cvt_pk_bf16_f32 v163, v166, v167
ds_write_b128 v194, v[160:163] offset:0
v_cvt_pk_bf16_f32 v168, v168, v169
v_cvt_pk_bf16_f32 v169, v170, v171
v_cvt_pk_bf16_f32 v170, v172, v173
v_cvt_pk_bf16_f32 v171, v174, v175
ds_write_b128 v194, v[168:171] offset:32
v_cvt_pk_bf16_f32 v176, v176, v177
v_cvt_pk_bf16_f32 v177, v178, v179
v_cvt_pk_bf16_f32 v178, v180, v181
v_cvt_pk_bf16_f32 v179, v182, v183
ds_write_b128 v194, v[176:179] offset:64
v_cvt_pk_bf16_f32 v184, v184, v185
v_cvt_pk_bf16_f32 v185, v186, v187
v_cvt_pk_bf16_f32 v186, v188, v189
v_cvt_pk_bf16_f32 v187, v190, v191
ds_write_b128 v194, v[184:187] offset:96
ds_read_b128 v[164:167], v195 offset:0
ds_read_b128 v[172:175], v195 offset:1152
ds_read_b128 v[180:183], v195 offset:2304
ds_read_b128 v[188:191], v195 offset:3456
s_mov_b32 s31, 4096
s_waitcnt lgkmcnt(3)
buffer_store_dwordx4 v[164:167], v197, s[20:23], s31 offen sc1 nt
s_mov_b32 s31, 0
s_waitcnt lgkmcnt(2)
buffer_store_dwordx4 v[172:175], v197, s[20:23], s31 offen sc1 nt
s_mov_b32 s31, 24576
s_waitcnt lgkmcnt(1)
buffer_store_dwordx4 v[180:183], v196, s[20:23], s31 offen sc1 nt
s_mov_b32 s31, 28672
s_waitcnt lgkmcnt(0)
s_mov_b32 exec_hi, 0x00ffffff
buffer_store_dwordx4 v[188:191], v196, s[20:23], s31 offen sc1 nt
s_mov_b64 exec, -1
s_endpgm
L_waitP5:
ds_read_b32 v200, v198
s_waitcnt lgkmcnt(0)
v_cmp_gt_u32 vcc, 5, v200
s_cbranch_vccnz L_waitP5
s_branch L_goP5
L_waitP10:
ds_read_b32 v200, v198
s_waitcnt lgkmcnt(0)
v_cmp_gt_u32 vcc, 10, v200
s_cbranch_vccnz L_waitP10
s_branch L_goP10
L_waitP20:
ds_read_b32 v200, v198
s_waitcnt lgkmcnt(0)
v_cmp_gt_u32 vcc, 20, v200
s_cbranch_vccnz L_waitP20
s_branch L_goP20
L_waitP30:
ds_read_b32 v200, v198
s_waitcnt lgkmcnt(0)
v_cmp_gt_u32 vcc, 30, v200
s_cbranch_vccnz L_waitP30
s_branch L_goP30
L_waitP35:
ds_read_b32 v200, v198
s_waitcnt lgkmcnt(0)
v_cmp_gt_u32 vcc, 35, v200
s_cbranch_vccnz L_waitP35
s_branch L_goP35
L_waitP40:
ds_read_b32 v200, v198
s_waitcnt lgkmcnt(0)
v_cmp_gt_u32 vcc, 40, v200
s_cbranch_vccnz L_waitP40
s_branch L_goP40
L_waitP50:
ds_read_b32 v200, v198
s_waitcnt lgkmcnt(0)
v_cmp_gt_u32 vcc, 50, v200
s_cbranch_vccnz L_waitP50
s_branch L_goP50
L_Q:
s_load_dwordx2 s[44:45], s[0:1], 32
s_mov_b32 s28, 0xbfb8aa3b
s_lshl_b32 s33, s3, 6
v_lshrrev_b32 v253, 2, v255
v_and_b32 v254, 3, v255
v_lshlrev_b32 v254, 4, v254
v_lshl_add_u32 v250, v253, 10, v254
v_add_u32 v250, s33, v250
v_add_u32 v208, 512, v250
s_lshr_b32 s101, s2, 3
s_lshl_b32 s101, s101, 14
s_mul_i32 s30, s34, 14336
s_add_u32 s30, s30, 100352
v_bfe_u32 v253, v255, 2, 2
v_lshlrev_b32 v249, 6, v253
v_bfe_u32 v253, v255, 4, 1
v_lshl_add_u32 v249, v253, 5, v249
v_lshrrev_b32 v253, 5, v255
v_lshl_add_u32 v249, v253, 9, v249
v_and_b32 v253, 3, v255
v_lshl_add_u32 v249, v253, 3, v249
v_add_u32 v249, s30, v249
v_lshrrev_b32 v253, 5, v255
v_and_b32 v254, 31, v255
v_xor_b32 v254, v254, v253
s_lshr_b32 s4, s2, 2
s_and_b32 s4, s4, 30
v_add_u32 v254, s4, v254
v_and_b32 v254, 31, v254
v_lshlrev_b32 v254, 4, v254
s_lshl_b32 s4, s34, 2
s_add_u32 s6, s29, s4
s_sub_u32 s7, s29, s4
s_sub_u32 s7, s7, 1
v_add_u32 v251, s6, v253
v_sub_u32 v252, s7, v253
v_lshl_add_u32 v251, v251, 9, v254
v_lshl_add_u32 v252, v252, 9, v254
s_mul_i32 s35, s34, 4224
v_bfe_u32 v253, v255, 1, 4
v_mul_u32_u24 v245, 1056, v253
v_and_b32 v253, 1, v255
v_lshl_add_u32 v245, v253, 9, v245
v_lshrrev_b32 v254, 5, v255
v_xor_b32 v253, v253, v254
v_lshl_add_u32 v245, v253, 4, v245
s_lshl_b32 s31, s3, 11
s_add_u32 s31, s31, 0
v_and_b32 v253, 31, v255
v_lshl_add_u32 v246, v253, 6, s31
v_bfe_u32 v253, v255, 1, 2
v_lshlrev_b32 v247, 1, v254
v_xor_b32 v253, v253, v247
v_lshl_add_u32 v246, v253, 4, v246
v_xor_b32 v247, 16, v246
v_and_b32 v248, 7, v255
v_lshlrev_b32 v248, 2, v248
v_add_u32 v248, 161792, v248
s_lshl_b32 s4, s3, 2
s_add_u32 s4, s4, 161792
v_mov_b32 v199, s4
v_mov_b32 v254, 0
ds_write_b32 v199, v254
s_lshl_b32 s52, s34, 10
s_lshl_b32 s53, s34, 7
v_lshrrev_b32 v253, 2, v255
v_and_b32 v254, 3, v255
v_lshlrev_b32 v254, 4, v254
v_lshl_add_u32 v192, v253, 9, v254
v_bfe_u32 v253, v255, 2, 2
v_lshlrev_b32 v193, 6, v253
v_bfe_u32 v253, v255, 4, 1
v_lshl_add_u32 v193, v253, 5, v193
v_lshrrev_b32 v253, 5, v255
v_lshl_add_u32 v193, v253, 8, v193
v_and_b32 v253, 1, v255
v_lshl_add_u32 v193, v253, 4, v193
v_bfe_u32 v253, v255, 1, 1
v_lshl_add_u32 v193, v253, 3, v193
v_add_u32 v193, s52, v193
s_add_u32 s52, s52, 100352
s_waitcnt lgkmcnt(0)
s_add_u32 s8, s36, s5
s_addc_u32 s9, s37, 0
s_mov_b64 s[12:13], s[38:39]
s_mov_b32 s14, 262144
s_mov_b32 s15, 0x20000
s_mov_b64 s[16:17], s[42:43]
s_mov_b32 s18, 131072
s_mov_b32 s19, 0x20000
s_mov_b64 s[24:25], s[40:41]
s_mov_b32 s26, 1536
s_mov_b32 s27, 0x20000
s_barrier
v_and_b32 v253, 31, v255
v_lshlrev_b32 v253, 1, v253
buffer_load_ushort v241, v253, s[24:27], s33 offen offset:0
buffer_load_ushort v240, v253, s[24:27], s33 offen offset:512
buffer_load_ushort v242, v253, s[24:27], s33 offen offset:1024
s_waitcnt vmcnt(0)
v_lshlrev_b32 v241, 16, v241
v_lshlrev_b32 v240, 16, v240
v_lshlrev_b32 v242, 16, v242
v_cmp_gt_u32 vcc, 32, v255
v_mul_f32 v241, s28, v241
v_mul_f32 v240, s28, v240
v_mul_f32 v242, s28, v242
v_cndmask_b32 v254, v241, v242, vcc
v_cndmask_b32 v242, v242, v241, vcc
v_mov_b32 v241, v254
v_max_f32 v254, abs(v241), abs(v242)
v_mul_f32 v254, 0x30800000, v254
v_max_f32 v254, 0x2b800000, v254
v_cmp_nge_f32 s[48:49], abs(v240), v254
v_mov_b32 v254, 0x53800000
v_cmp_nle_f32 s[50:51], abs(v240), v254
v_rcp_f32 v254, v240
s_nop 3
s_or_b64 s[48:49], s[48:49], s[50:51]
s_cselect_b64 vcc, -1, 0
s_cselect_b32 s32, 1, 0
v_cndmask_b32 v240, v254, v240, vcc
v_cndmask_b32 v254, v254, 1.0, vcc
v_mul_f32 v241, v241, v254
v_mul_f32 v242, v242, v254
v_mov_b32 v254, 5
ds_write_b32 v199, v254
s_barrier
s_add_u32 m0, s30, 0
s_and_b32 s100, s101, 0x3ffff
buffer_load_dwordx4 v250, s[12:15], s100 offen lds
s_add_u32 m0, s30, 1024
s_add_u32 s101, s100, 16384
buffer_load_dwordx4 v208, s[12:15], s100 offen lds
s_add_u32 m0, s30, 2048
s_and_b32 s100, s101, 0x3ffff
buffer_load_dwordx4 v250, s[12:15], s100 offen lds
s_add_u32 m0, s30, 3072
s_add_u32 s101, s100, 16384
buffer_load_dwordx4 v208, s[12:15], s100 offen lds
s_add_u32 m0, s30, 4096
s_and_b32 s100, s101, 0x3ffff
buffer_load_dwordx4 v250, s[12:15], s100 offen lds
s_add_u32 m0, s30, 5120
s_add_u32 s101, s100, 16384
buffer_load_dwordx4 v208, s[12:15], s100 offen lds
s_add_u32 m0, s30, 6144
s_and_b32 s100, s101, 0x3ffff
buffer_load_dwordx4 v250, s[12:15], s100 offen lds
s_add_u32 m0, s30, 7168
s_add_u32 s101, s100, 16384
buffer_load_dwordx4 v208, s[12:15], s100 offen lds
s_add_u32 m0, s30, 8192
s_and_b32 s100, s101, 0x3ffff
buffer_load_dwordx4 v250, s[12:15], s100 offen lds
s_add_u32 m0, s30, 9216
s_add_u32 s101, s100, 16384
buffer_load_dwordx4 v208, s[12:15], s100 offen lds
s_add_u32 m0, s30, 10240
s_and_b32 s100, s101, 0x3ffff
buffer_load_dwordx4 v250, s[12:15], s100 offen lds
s_add_u32 m0, s30, 11264
s_add_u32 s101, s100, 16384
buffer_load_dwordx4 v208, s[12:15], s100 offen lds
s_add_u32 m0, s30, 12288
s_and_b32 s100, s101, 0x3ffff
buffer_load_dwordx4 v250, s[12:15], s100 offen lds
s_add_u32 m0, s30, 13312
s_add_u32 s101, s100, 16384
buffer_load_dwordx4 v208, s[12:15], s100 offen lds
ds_read_b128 v[224:227], v245 offset:0
ds_read_b128 v[228:231], v245 offset:16896
ds_read_b128 v[232:235], v245 offset:32
ds_read_b128 v[236:239], v245 offset:16928
s_waitcnt vmcnt(13)
ds_read_b64_tr_b16 v[0:1], v249 offset:0
ds_read_b64_tr_b16 v[2:3], v249 offset:256
s_waitcnt vmcnt(12)
ds_read_b64_tr_b16 v[4:5], v249 offset:1024
ds_read_b64_tr_b16 v[6:7], v249 offset:1280
s_waitcnt lgkmcnt(2)
s_add_u32 m0, s30, 0
s_and_b32 s100, s101, 0x3ffff
buffer_load_dwordx4 v250, s[12:15], s100 offen lds
s_waitcnt vmcnt(12)
ds_read_b64_tr_b16 v[8:9], v249 offset:2048
ds_read_b64_tr_b16 v[10:11], v249 offset:2304
s_waitcnt lgkmcnt(2)
s_add_u32 m0, s30, 1024
s_add_u32 s101, s100, 16384
buffer_load_dwordx4 v208, s[12:15], s100 offen lds
s_waitcnt vmcnt(12)
ds_read_b64_tr_b16 v[12:13], v249 offset:3072
ds_read_b64_tr_b16 v[14:15], v249 offset:3328
s_waitcnt lgkmcnt(2)
s_add_u32 m0, s30, 2048
s_and_b32 s100, s101, 0x3ffff
buffer_load_dwordx4 v250, s[12:15], s100 offen lds
s_waitcnt lgkmcnt(0)
s_add_u32 m0, s30, 3072
s_add_u32 s101, s100, 16384
buffer_load_dwordx4 v208, s[12:15], s100 offen lds
v_mfma_f32_32x32x16_bf16 v[144:159], v[224:227], v[4:7], 0
s_waitcnt vmcnt(13)
ds_read_b64_tr_b16 v[16:17], v249 offset:4096
ds_read_b64_tr_b16 v[18:19], v249 offset:4352
v_mfma_f32_32x32x16_bf16 v[128:143], v[224:227], v[0:3], 0
ds_read_b128 v[224:227], v245 offset:64
v_mfma_f32_32x32x16_bf16 v[176:191], v[228:231], v[4:7], 0
s_waitcnt vmcnt(12)
ds_read_b64_tr_b16 v[20:21], v249 offset:5120
ds_read_b64_tr_b16 v[22:23], v249 offset:5376
v_mfma_f32_32x32x16_bf16 v[160:175], v[228:231], v[0:3], 0
ds_read_b128 v[228:231], v245 offset:16960
v_mfma_f32_32x32x16_bf16 v[144:159], v[232:235], v[12:15], v[144:159]
s_waitcnt vmcnt(11)
ds_read_b64_tr_b16 v[24:25], v249 offset:6144
ds_read_b64_tr_b16 v[26:27], v249 offset:6400
v_mfma_f32_32x32x16_bf16 v[128:143], v[232:235], v[8:11], v[128:143]
ds_read_b128 v[232:235], v245 offset:96
v_mfma_f32_32x32x16_bf16 v[176:191], v[236:239], v[12:15], v[176:191]
s_waitcnt lgkmcnt(7)
s_add_u32 m0, s30, 4096
s_and_b32 s100, s101, 0x3ffff
buffer_load_dwordx4 v250, s[12:15], s100 offen lds
s_waitcnt vmcnt(11)
ds_read_b64_tr_b16 v[28:29], v249 offset:7168
v_mfma_f32_32x32x16_bf16 v[160:175], v[236:239], v[8:11], v[160:175]
ds_read_b128 v[236:239], v245 offset:16992
ds_read_b64_tr_b16 v[30:31], v249 offset:7424
s_waitcnt lgkmcnt(7)
v_mfma_f32_32x32x16_bf16 v[144:159], v[224:227], v[20:23], v[144:159]
s_add_u32 m0, s30, 5120
s_add_u32 s101, s100, 16384
buffer_load_dwordx4 v208, s[12:15], s100 offen lds
s_waitcnt vmcnt(11)
ds_read_b64_tr_b16 v[32:33], v249 offset:8192
v_mfma_f32_32x32x16_bf16 v[128:143], v[224:227], v[16:19], v[128:143]
ds_read_b128 v[224:227], v245 offset:128
ds_read_b64_tr_b16 v[34:35], v249 offset:8448
s_waitcnt lgkmcnt(9)
v_mfma_f32_32x32x16_bf16 v[176:191], v[228:231], v[20:23], v[176:191]
s_waitcnt lgkmcnt(7)
s_add_u32 m0, s30, 6144
s_and_b32 s100, s101, 0x3ffff
buffer_load_dwordx4 v250, s[12:15], s100 offen lds
s_waitcnt vmcnt(11)
ds_read_b64_tr_b16 v[36:37], v249 offset:9216
v_mfma_f32_32x32x16_bf16 v[160:175], v[228:231], v[16:19], v[160:175]
ds_read_b128 v[228:231], v245 offset:17024
ds_read_b64_tr_b16 v[38:39], v249 offset:9472
s_waitcnt lgkmcnt(6)
v_mfma_f32_32x32x16_bf16 v[144:159], v[232:235], v[28:31], v[144:159]
s_add_u32 m0, s30, 7168
s_add_u32 s101, s100, 16384
buffer_load_dwordx4 v208, s[12:15], s100 offen lds
s_waitcnt vmcnt(11)
ds_read_b64_tr_b16 v[40:41], v249 offset:10240
v_mfma_f32_32x32x16_bf16 v[128:143], v[232:235], v[24:27], v[128:143]
ds_read_b128 v[232:235], v245 offset:160
ds_read_b64_tr_b16 v[42:43], v249 offset:10496
v_mfma_f32_32x32x16_bf16 v[176:191], v[236:239], v[28:31], v[176:191]
s_waitcnt lgkmcnt(6)
s_add_u32 m0, s30, 8192
s_and_b32 s100, s101, 0x3ffff
buffer_load_dwordx4 v250, s[12:15], s100 offen lds
s_waitcnt vmcnt(11)
ds_read_b64_tr_b16 v[44:45], v249 offset:11264
v_mfma_f32_32x32x16_bf16 v[160:175], v[236:239], v[24:27], v[160:175]
ds_read_b128 v[236:239], v245 offset:17056
ds_read_b64_tr_b16 v[46:47], v249 offset:11520
s_waitcnt lgkmcnt(6)
v_mfma_f32_32x32x16_bf16 v[144:159], v[224:227], v[36:39], v[144:159]
s_add_u32 m0, s30, 9216
s_add_u32 s101, s100, 16384
buffer_load_dwordx4 v208, s[12:15], s100 offen lds
s_waitcnt vmcnt(11)
ds_read_b64_tr_b16 v[48:49], v249 offset:12288
v_mfma_f32_32x32x16_bf16 v[128:143], v[224:227], v[32:35], v[128:143]
ds_read_b128 v[224:227], v245 offset:192
ds_read_b64_tr_b16 v[50:51], v249 offset:12544
v_mfma_f32_32x32x16_bf16 v[176:191], v[228:231], v[36:39], v[176:191]
s_waitcnt lgkmcnt(6)
s_add_u32 m0, s30, 10240
s_and_b32 s100, s101, 0x3ffff
buffer_load_dwordx4 v250, s[12:15], s100 offen lds
s_waitcnt vmcnt(11)
ds_read_b64_tr_b16 v[52:53], v249 offset:13312
v_mfma_f32_32x32x16_bf16 v[160:175], v[228:231], v[32:35], v[160:175]
ds_read_b128 v[228:231], v245 offset:17088
ds_read_b64_tr_b16 v[54:55], v249 offset:13568
s_waitcnt lgkmcnt(6)
v_mfma_f32_32x32x16_bf16 v[144:159], v[232:235], v[44:47], v[144:159]
s_add_u32 m0, s30, 11264
s_add_u32 s101, s100, 16384
buffer_load_dwordx4 v208, s[12:15], s100 offen lds
s_waitcnt vmcnt(11)
ds_read_b64_tr_b16 v[56:57], v249 offset:0
v_mfma_f32_32x32x16_bf16 v[128:143], v[232:235], v[40:43], v[128:143]
ds_read_b128 v[232:235], v245 offset:224
ds_read_b64_tr_b16 v[58:59], v249 offset:256
v_mfma_f32_32x32x16_bf16 v[176:191], v[236:239], v[44:47], v[176:191]
s_waitcnt lgkmcnt(6)
s_add_u32 m0, s30, 12288
s_and_b32 s100, s101, 0x3ffff
buffer_load_dwordx4 v250, s[12:15], s100 offen lds
s_waitcnt vmcnt(11)
ds_read_b64_tr_b16 v[60:61], v249 offset:1024
v_mfma_f32_32x32x16_bf16 v[160:175], v[236:239], v[40:43], v[160:175]
ds_read_b128 v[236:239], v245 offset:17120
ds_read_b64_tr_b16 v[62:63], v249 offset:1280
s_waitcnt lgkmcnt(6)
v_mfma_f32_32x32x16_bf16 v[144:159], v[224:227], v[52:55], v[144:159]
s_add_u32 m0, s30, 13312
s_add_u32 s101, s100, 16384
buffer_load_dwordx4 v208, s[12:15], s100 offen lds
s_waitcnt vmcnt(11)
ds_read_b64_tr_b16 v[64:65], v249 offset:2048
v_mfma_f32_32x32x16_bf16 v[128:143], v[224:227], v[48:51], v[128:143]
ds_read_b128 v[224:227], v245 offset:256
ds_read_b64_tr_b16 v[66:67], v249 offset:2304
v_mfma_f32_32x32x16_bf16 v[176:191], v[228:231], v[52:55], v[176:191]
s_waitcnt lgkmcnt(6)
s_add_u32 m0, s30, 0
s_and_b32 s100, s101, 0x3ffff
buffer_load_dwordx4 v250, s[12:15], s100 offen lds
s_waitcnt vmcnt(11)
ds_read_b64_tr_b16 v[68:69], v249 offset:3072
v_mfma_f32_32x32x16_bf16 v[160:175], v[228:231], v[48:51], v[160:175]
ds_read_b128 v[228:231], v245 offset:17152
ds_read_b64_tr_b16 v[70:71], v249 offset:3328
s_waitcnt lgkmcnt(6)
v_mfma_f32_32x32x16_bf16 v[144:159], v[232:235], v[60:63], v[144:159]
s_add_u32 m0, s30, 1024
s_add_u32 s101, s100, 16384
buffer_load_dwordx4 v208, s[12:15], s100 offen lds
ds_read_b32 v253, v248
v_mfma_f32_32x32x16_bf16 v[128:143], v[232:235], v[56:59], v[128:143]
ds_read_b128 v[232:235], v245 offset:288
s_waitcnt vmcnt(11)
ds_read_b64_tr_b16 v[72:73], v249 offset:4096
v_mfma_f32_32x32x16_bf16 v[176:191], v[236:239], v[60:63], v[176:191]
ds_read_b64_tr_b16 v[74:75], v249 offset:4352
s_waitcnt lgkmcnt(7)
s_add_u32 m0, s30, 2048
s_and_b32 s100, s101, 0x3ffff
buffer_load_dwordx4 v250, s[12:15], s100 offen lds
v_mfma_f32_32x32x16_bf16 v[160:175], v[236:239], v[56:59], v[160:175]
ds_read_b128 v[236:239], v245 offset:17184
s_waitcnt vmcnt(11)
ds_read_b64_tr_b16 v[76:77], v249 offset:5120
s_waitcnt lgkmcnt(6)
v_mfma_f32_32x32x16_bf16 v[144:159], v[224:227], v[68:71], v[144:159]
ds_read_b64_tr_b16 v[78:79], v249 offset:5376
s_waitcnt lgkmcnt(6)
v_cmp_gt_u32 vcc, 5, v253
s_cbranch_vccnz L_waitQh5
L_goQh5:
v_mfma_f32_32x32x16_bf16 v[128:143], v[224:227], v[64:67], v[128:143]
ds_read_b128 v[224:227], v245 offset:320
s_add_u32 m0, s30, 3072
s_add_u32 s101, s100, 16384
buffer_load_dwordx4 v208, s[12:15], s100 offen lds
v_mfma_f32_32x32x16_bf16 v[176:191], v[228:231], v[68:71], v[176:191]
s_waitcnt vmcnt(11)
ds_read_b64_tr_b16 v[80:81], v249 offset:6144
s_add_u32 m0, s35, 66560
v_subrev_u32 v253, 16384, v252
buffer_load_dwordx4 v253, s[8:11], 0 offen nt lds
v_mfma_f32_32x32x16_bf16 v[160:175], v[228:231], v[64:67], v[160:175]
ds_read_b128 v[228:231], v245 offset:17216
ds_read_b64_tr_b16 v[82:83], v249 offset:6400
s_waitcnt lgkmcnt(4)
v_mfma_f32_32x32x16_bf16 v[144:159], v[232:235], v[76:79], v[144:159]
s_waitcnt vmcnt(11)
ds_read_b64_tr_b16 v[84:85], v249 offset:7168
s_add_u32 m0, s35, 67616
v_subrev_u32 v253, 17408, v252
buffer_load_dwordx4 v253, s[8:11], 0 offen nt lds
v_mfma_f32_32x32x16_bf16 v[128:143], v[232:235], v[72:75], v[128:143]
ds_read_b128 v[232:235], v245 offset:352
ds_read_b64_tr_b16 v[86:87], v249 offset:7424
v_mfma_f32_32x32x16_bf16 v[176:191], v[236:239], v[76:79], v[176:191]
s_waitcnt vmcnt(11)
ds_read_b64_tr_b16 v[88:89], v249 offset:8192
s_add_u32 m0, s35, 68672
v_add_u32 v253, 16384, v251
buffer_load_dwordx4 v253, s[8:11], 0 offen nt lds
v_mfma_f32_32x32x16_bf16 v[160:175], v[236:239], v[72:75], v[160:175]
ds_read_b128 v[236:239], v245 offset:17248
ds_read_b64_tr_b16 v[90:91], v249 offset:8448
s_waitcnt lgkmcnt(3)
v_mfma_f32_32x32x16_bf16 v[144:159], v[224:227], v[84:87], v[144:159]
s_waitcnt vmcnt(11)
ds_read_b64_tr_b16 v[92:93], v249 offset:9216
s_add_u32 m0, s35, 69728
v_add_u32 v253, 17408, v251
buffer_load_dwordx4 v253, s[8:11], 0 offen nt lds
v_mfma_f32_32x32x16_bf16 v[128:143], v[224:227], v[80:83], v[128:143]
ds_read_b128 v[224:227], v245 offset:384
ds_read_b64_tr_b16 v[94:95], v249 offset:9472
v_mfma_f32_32x32x16_bf16 v[176:191], v[228:231], v[84:87], v[176:191]
s_waitcnt vmcnt(11)
ds_read_b64_tr_b16 v[96:97], v249 offset:10240
s_add_u32 m0, s35, 83456
v_subrev_u32 v253, 24576, v252
buffer_load_dwordx4 v253, s[8:11], 0 offen nt lds
v_mfma_f32_32x32x16_bf16 v[160:175], v[228:231], v[80:83], v[160:175]
ds_read_b128 v[228:231], v245 offset:17280
ds_read_b64_tr_b16 v[98:99], v249 offset:10496
s_waitcnt lgkmcnt(3)
v_mfma_f32_32x32x16_bf16 v[144:159], v[232:235], v[92:95], v[144:159]
s_waitcnt vmcnt(11)
ds_read_b64_tr_b16 v[100:101], v249 offset:11264
s_add_u32 m0, s35, 84512
v_subrev_u32 v253, 25600, v252
buffer_load_dwordx4 v253, s[8:11], 0 offen nt lds
v_mfma_f32_32x32x16_bf16 v[128:143], v[232:235], v[88:91], v[128:143]
ds_read_b128 v[232:235], v245 offset:416
ds_read_b64_tr_b16 v[102:103], v249 offset:11520
v_mfma_f32_32x32x16_bf16 v[176:191], v[236:239], v[92:95], v[176:191]
s_waitcnt vmcnt(11)
ds_read_b64_tr_b16 v[104:105], v249 offset:12288
s_add_u32 m0, s35, 85568
v_add_u32 v253, 24576, v251
buffer_load_dwordx4 v253, s[8:11], 0 offen nt lds
v_mfma_f32_32x32x16_bf16 v[160:175], v[236:239], v[88:91], v[160:175]
ds_read_b128 v[236:239], v245 offset:17312
ds_read_b64_tr_b16 v[106:107], v249 offset:12544
s_waitcnt lgkmcnt(3)
v_mfma_f32_32x32x16_bf16 v[144:159], v[224:227], v[100:103], v[144:159]
s_waitcnt vmcnt(11)
ds_read_b64_tr_b16 v[108:109], v249 offset:13312
s_add_u32 m0, s35, 86624
v_add_u32 v253, 25600, v251
buffer_load_dwordx4 v253, s[8:11], 0 offen nt lds
v_mfma_f32_32x32x16_bf16 v[128:143], v[224:227], v[96:99], v[128:143]
ds_read_b128 v[224:227], v245 offset:448
ds_read_b64_tr_b16 v[110:111], v249 offset:13568
v_mfma_f32_32x32x16_bf16 v[176:191], v[228:231], v[100:103], v[176:191]
s_waitcnt vmcnt(11)
ds_read_b64_tr_b16 v[112:113], v249 offset:0
ds_read_b64_tr_b16 v[114:115], v249 offset:256
v_mfma_f32_32x32x16_bf16 v[160:175], v[228:231], v[96:99], v[160:175]
ds_read_b128 v[228:231], v245 offset:17344
s_waitcnt vmcnt(10)
ds_read_b64_tr_b16 v[116:117], v249 offset:1024
s_waitcnt lgkmcnt(4)
v_mfma_f32_32x32x16_bf16 v[144:159], v[232:235], v[108:111], v[144:159]
ds_read_b64_tr_b16 v[118:119], v249 offset:1280
v_mfma_f32_32x32x16_bf16 v[128:143], v[232:235], v[104:107], v[128:143]
ds_read_b128 v[232:235], v245 offset:480
s_waitcnt vmcnt(9)
ds_read_b64_tr_b16 v[120:121], v249 offset:2048
v_mfma_f32_32x32x16_bf16 v[176:191], v[236:239], v[108:111], v[176:191]
ds_read_b64_tr_b16 v[122:123], v249 offset:2304
v_mfma_f32_32x32x16_bf16 v[160:175], v[236:239], v[104:107], v[160:175]
ds_read_b128 v[236:239], v245 offset:17376
s_waitcnt vmcnt(8)
ds_read_b64_tr_b16 v[124:125], v249 offset:3072
s_waitcnt lgkmcnt(5)
v_mfma_f32_32x32x16_bf16 v[144:159], v[224:227], v[116:119], v[144:159]
ds_read_b64_tr_b16 v[126:127], v249 offset:3328
v_mfma_f32_32x32x16_bf16 v[128:143], v[224:227], v[112:115], v[128:143]
v_mfma_f32_32x32x16_bf16 v[176:191], v[228:231], v[116:119], v[176:191]
v_mfma_f32_32x32x16_bf16 v[160:175], v[228:231], v[112:115], v[160:175]
s_waitcnt lgkmcnt(0)
v_mfma_f32_32x32x16_bf16 v[144:159], v[232:235], v[124:127], v[144:159]
v_mfma_f32_32x32x16_bf16 v[128:143], v[232:235], v[120:123], v[128:143]
v_mfma_f32_32x32x16_bf16 v[176:191], v[236:239], v[124:127], v[176:191]
v_mfma_f32_32x32x16_bf16 v[160:175], v[236:239], v[120:123], v[160:175]
v_mov_b32 v249, v199
v_mov_b32 v250, v192
s_cmp_lg_u32 s32, 0
s_cbranch_scc1 L_slowQ
s_nop 5
s_waitcnt vmcnt(4)
v_mov_b32 v254, 10
ds_write_b32 v249, v254
v_mul_f32 v144, s28, v144
v_mul_f32 v145, s28, v145
v_mul_f32 v146, s28, v146
v_mul_f32 v147, s28, v147
v_mul_f32 v148, s28, v148
v_mul_f32 v149, s28, v149
v_mul_f32 v150, s28, v150
v_mul_f32 v151, s28, v151
v_mul_f32 v152, s28, v152
v_mul_f32 v153, s28, v153
v_mul_f32 v154, s28, v154
v_mul_f32 v155, s28, v155
v_mul_f32 v156, s28, v156
v_mul_f32 v157, s28, v157
v_mul_f32 v158, s28, v158
v_mul_f32 v159, s28, v159
v_exp_f32 v144, v144
v_exp_f32 v145, v145
v_exp_f32 v146, v146
v_exp_f32 v147, v147
v_exp_f32 v148, v148
v_exp_f32 v149, v149
v_exp_f32 v150, v150
v_exp_f32 v151, v151
v_exp_f32 v152, v152
v_exp_f32 v153, v153
v_exp_f32 v154, v154
v_exp_f32 v155, v155
v_exp_f32 v156, v156
v_exp_f32 v157, v157
v_exp_f32 v158, v158
v_exp_f32 v159, v159
v_fma_f32 v144, v144, v240, v240
v_fma_f32 v145, v145, v240, v240
v_fma_f32 v146, v146, v240, v240
v_fma_f32 v147, v147, v240, v240
v_fma_f32 v148, v148, v240, v240
v_fma_f32 v149, v149, v240, v240
v_fma_f32 v150, v150, v240, v240
v_fma_f32 v151, v151, v240, v240
v_fma_f32 v152, v152, v240, v240
v_fma_f32 v153, v153, v240, v240
v_fma_f32 v154, v154, v240, v240
v_fma_f32 v155, v155, v240, v240
v_fma_f32 v156, v156, v240, v240
v_fma_f32 v157, v157, v240, v240
v_fma_f32 v158, v158, v240, v240
v_fma_f32 v159, v159, v240, v240
v_rcp_f32 v144, v144
v_rcp_f32 v145, v145
v_rcp_f32 v146, v146
v_rcp_f32 v147, v147
v_rcp_f32 v148, v148
v_rcp_f32 v149, v149
v_rcp_f32 v150, v150
v_rcp_f32 v151, v151
v_rcp_f32 v152, v152
v_rcp_f32 v153, v153
v_rcp_f32 v154, v154
v_rcp_f32 v155, v155
v_rcp_f32 v156, v156
v_rcp_f32 v157, v157
v_rcp_f32 v158, v158
v_rcp_f32 v159, v159
v_mul_f32 v128, v128, v144
v_mul_f32 v129, v129, v145
v_mov_b32 v243, v128
v_mov_b32 v244, v128
v_cmp_gt_u32 vcc, 32, v255
v_mul_f32 v130, v130, v146
v_mul_f32 v131, v131, v147
v_mul_f32 v132, v132, v148
v_permlane32_swap_b32 v243, v244
v_mul_f32 v133, v133, v149
v_mul_f32 v134, v134, v150
v_mul_f32 v135, v135, v151
v_cndmask_b32 v244, v243, v244, vcc
v_mul_f32 v136, v136, v152
v_mul_f32 v137, v137, v153
v_mul_f32 v138, v138, v154
v_mul_f32 v139, v139, v155
v_mul_f32 v140, v140, v156
v_mul_f32 v141, v141, v157
v_mul_f32 v251, v142, v158
v_mul_f32 v252, v143, v159
v_fma_f32 v144, v242, v128, v244
v_fma_f32 v145, v242, v129, v128
v_fma_f32 v146, v242, v130, v129
v_fma_f32 v147, v242, v131, v130
v_fma_f32 v148, v242, v132, v131
v_fma_f32 v149, v242, v133, v132
v_fma_f32 v150, v242, v134, v133
v_fma_f32 v151, v242, v135, v134
v_fma_f32 v152, v242, v136, v135
v_fma_f32 v153, v242, v137, v136
v_fma_f32 v154, v242, v138, v137
v_fma_f32 v155, v242, v139, v138
v_fma_f32 v156, v242, v140, v139
v_fma_f32 v157, v242, v141, v140
v_fma_f32 v158, v242, v251, v141
s_waitcnt vmcnt(0)
v_mov_b32 v254, 25
ds_write_b32 v249, v254
s_setprio 1
v_fma_f32 v159, v242, v252, v251
v_fmac_f32 v144, v241, v243
v_fmac_f32 v145, v241, v244
v_fmac_f32 v146, v241, v128
v_fmac_f32 v147, v241, v129
v_fmac_f32 v148, v241, v130
v_fmac_f32 v149, v241, v131
v_fmac_f32 v150, v241, v132
v_fmac_f32 v151, v241, v133
v_fmac_f32 v152, v241, v134
v_fmac_f32 v153, v241, v135
v_fmac_f32 v154, v241, v136
v_fmac_f32 v155, v241, v137
v_fmac_f32 v156, v241, v138
v_fmac_f32 v157, v241, v139
v_fmac_f32 v158, v241, v140
v_fmac_f32 v159, v241, v141
v_exp_f32 v128, v144
v_exp_f32 v129, v145
v_exp_f32 v130, v146
v_exp_f32 v131, v147
v_exp_f32 v132, v148
v_exp_f32 v133, v149
v_exp_f32 v134, v150
v_exp_f32 v135, v151
v_fma_f32 v128, v128, s28, s28
v_fma_f32 v129, v129, s28, s28
v_fma_f32 v130, v130, s28, s28
v_fma_f32 v131, v131, s28, s28
v_fma_f32 v132, v132, s28, s28
v_fma_f32 v133, v133, s28, s28
v_fma_f32 v134, v134, s28, s28
v_fma_f32 v135, v135, s28, s28
v_rcp_f32 v128, v128
v_rcp_f32 v129, v129
v_rcp_f32 v130, v130
v_rcp_f32 v131, v131
v_rcp_f32 v132, v132
v_rcp_f32 v133, v133
v_rcp_f32 v134, v134
v_rcp_f32 v135, v135
v_mul_f32 v144, v144, v128
v_mul_f32 v145, v145, v129
v_mul_f32 v146, v146, v130
v_mul_f32 v147, v147, v131
v_mul_f32 v148, v148, v132
v_mul_f32 v149, v149, v133
v_mul_f32 v150, v150, v134
v_mul_f32 v151, v151, v135
v_cvt_pk_bf16_f32 v128, v144, v145
v_cvt_pk_bf16_f32 v129, v146, v147
v_cvt_pk_bf16_f32 v130, v148, v149
v_cvt_pk_bf16_f32 v131, v150, v151
ds_write_b128 v246, v[128:131] offset:33792
v_exp_f32 v136, v152
v_exp_f32 v137, v153
v_exp_f32 v138, v154
v_exp_f32 v139, v155
v_exp_f32 v140, v156
v_exp_f32 v141, v157
v_exp_f32 v142, v158
v_exp_f32 v143, v159
v_fma_f32 v136, v136, s28, s28
v_fma_f32 v137, v137, s28, s28
v_fma_f32 v138, v138, s28, s28
v_fma_f32 v139, v139, s28, s28
v_fma_f32 v140, v140, s28, s28
v_fma_f32 v141, v141, s28, s28
v_fma_f32 v142, v142, s28, s28
v_fma_f32 v143, v143, s28, s28
v_rcp_f32 v136, v136
v_rcp_f32 v137, v137
v_rcp_f32 v138, v138
v_rcp_f32 v139, v139
v_rcp_f32 v140, v140
v_rcp_f32 v141, v141
v_rcp_f32 v142, v142
v_rcp_f32 v143, v143
v_mul_f32 v152, v152, v136
v_mul_f32 v153, v153, v137
v_mul_f32 v154, v154, v138
v_mul_f32 v155, v155, v139
v_mul_f32 v156, v156, v140
v_mul_f32 v157, v157, v141
v_mul_f32 v158, v158, v142
v_mul_f32 v159, v159, v143
v_cvt_pk_bf16_f32 v136, v152, v153
v_cvt_pk_bf16_f32 v137, v154, v155
v_cvt_pk_bf16_f32 v138, v156, v157
v_cvt_pk_bf16_f32 v139, v158, v159
ds_write_b128 v247, v[136:139] offset:33792
v_mul_f32 v176, s28, v176
v_mul_f32 v177, s28, v177
v_mul_f32 v178, s28, v178
v_mul_f32 v179, s28, v179
v_mul_f32 v180, s28, v180
v_mul_f32 v181, s28, v181
v_mul_f32 v182, s28, v182
v_mul_f32 v183, s28, v183
v_mul_f32 v184, s28, v184
v_mul_f32 v185, s28, v185
ds_read_b32 v253, v248
v_mul_f32 v186, s28, v186
v_mul_f32 v187, s28, v187
v_mul_f32 v188, s28, v188
v_mul_f32 v189, s28, v189
v_mul_f32 v190, s28, v190
v_mul_f32 v191, s28, v191
v_exp_f32 v176, v176
v_exp_f32 v177, v177
v_exp_f32 v178, v178
v_exp_f32 v179, v179
v_exp_f32 v180, v180
v_exp_f32 v181, v181
v_exp_f32 v182, v182
v_exp_f32 v183, v183
v_exp_f32 v184, v184
s_waitcnt lgkmcnt(0)
v_cmp_gt_u32 vcc, 20, v253
s_cbranch_vccnz L_waitQ20
L_goQ20:
v_exp_f32 v185, v185
v_exp_f32 v186, v186
v_exp_f32 v187, v187
v_exp_f32 v188, v188
v_exp_f32 v189, v189
v_exp_f32 v190, v190
v_exp_f32 v191, v191
v_fma_f32 v176, v176, v240, v240
v_fma_f32 v177, v177, v240, v240
v_fma_f32 v178, v178, v240, v240
v_fma_f32 v179, v179, v240, v240
v_fma_f32 v180, v180, v240, v240
v_fma_f32 v181, v181, v240, v240
v_fma_f32 v182, v182, v240, v240
v_fma_f32 v183, v183, v240, v240
v_fma_f32 v184, v184, v240, v240
v_fma_f32 v185, v185, v240, v240
v_fma_f32 v186, v186, v240, v240
v_fma_f32 v187, v187, v240, v240
v_fma_f32 v188, v188, v240, v240
v_fma_f32 v189, v189, v240, v240
v_fma_f32 v190, v190, v240, v240
v_fma_f32 v191, v191, v240, v240
v_rcp_f32 v176, v176
v_rcp_f32 v177, v177
v_rcp_f32 v178, v178
v_rcp_f32 v179, v179
v_rcp_f32 v180, v180
v_rcp_f32 v181, v181
v_rcp_f32 v182, v182
v_rcp_f32 v183, v183
v_rcp_f32 v184, v184
v_rcp_f32 v185, v185
v_rcp_f32 v186, v186
v_rcp_f32 v187, v187
v_rcp_f32 v188, v188
v_rcp_f32 v189, v189
v_rcp_f32 v190, v190
v_rcp_f32 v191, v191
v_mul_f32 v160, v160, v176
v_mul_f32 v161, v161, v177
v_mul_f32 v162, v162, v178
v_mul_f32 v163, v163, v179
v_mul_f32 v164, v164, v180
v_mul_f32 v165, v165, v181
v_mul_f32 v166, v166, v182
v_mul_f32 v167, v167, v183
v_mul_f32 v168, v168, v184
v_mul_f32 v169, v169, v185
v_mul_f32 v170, v170, v186
v_mul_f32 v171, v171, v187
v_mul_f32 v172, v172, v188
v_mul_f32 v173, v173, v189
v_mul_f32 v243, v174, v190
v_mul_f32 v244, v175, v191
v_fma_f32 v176, v242, v160, v252
v_fma_f32 v177, v242, v161, v160
v_fma_f32 v178, v242, v162, v161
v_fma_f32 v179, v242, v163, v162
v_fma_f32 v180, v242, v164, v163
v_fma_f32 v181, v242, v165, v164
v_fma_f32 v182, v242, v166, v165
v_fma_f32 v183, v242, v167, v166
v_fma_f32 v184, v242, v168, v167
v_fma_f32 v185, v242, v169, v168
v_fma_f32 v186, v242, v170, v169
v_fma_f32 v187, v242, v171, v170
v_fma_f32 v188, v242, v172, v171
v_fma_f32 v189, v242, v173, v172
v_fma_f32 v190, v242, v243, v173
v_fma_f32 v191, v242, v244, v243
v_fmac_f32 v176, v241, v251
v_fmac_f32 v177, v241, v252
v_fmac_f32 v178, v241, v160
v_fmac_f32 v179, v241, v161
v_fmac_f32 v180, v241, v162
v_fmac_f32 v181, v241, v163
v_fmac_f32 v182, v241, v164
v_fmac_f32 v183, v241, v165
v_fmac_f32 v184, v241, v166
v_fmac_f32 v185, v241, v167
v_fmac_f32 v186, v241, v168
v_fmac_f32 v187, v241, v169
v_fmac_f32 v188, v241, v170
v_fmac_f32 v189, v241, v171
v_fmac_f32 v190, v241, v172
v_fmac_f32 v191, v241, v173
v_exp_f32 v160, v176
v_exp_f32 v161, v177
v_exp_f32 v162, v178
v_exp_f32 v163, v179
v_exp_f32 v164, v180
v_exp_f32 v165, v181
v_exp_f32 v166, v182
v_exp_f32 v167, v183
v_fma_f32 v160, v160, s28, s28
v_fma_f32 v161, v161, s28, s28
v_fma_f32 v162, v162, s28, s28
v_fma_f32 v163, v163, s28, s28
v_fma_f32 v164, v164, s28, s28
v_fma_f32 v165, v165, s28, s28
v_fma_f32 v166, v166, s28, s28
v_fma_f32 v167, v167, s28, s28
v_rcp_f32 v160, v160
v_rcp_f32 v161, v161
v_rcp_f32 v162, v162
v_rcp_f32 v163, v163
v_rcp_f32 v164, v164
v_rcp_f32 v165, v165
v_rcp_f32 v166, v166
v_rcp_f32 v167, v167
v_mul_f32 v176, v176, v160
v_mul_f32 v177, v177, v161
v_mul_f32 v178, v178, v162
v_mul_f32 v179, v179, v163
v_mul_f32 v180, v180, v164
v_mul_f32 v181, v181, v165
v_mul_f32 v182, v182, v166
v_mul_f32 v183, v183, v167
v_cvt_pk_bf16_f32 v160, v176, v177
v_cvt_pk_bf16_f32 v161, v178, v179
v_cvt_pk_bf16_f32 v162, v180, v181
v_cvt_pk_bf16_f32 v163, v182, v183
ds_write_b128 v246, v[160:163] offset:50176
v_exp_f32 v168, v184
s_setprio 0
v_add_u32 v245, 66560, v245
ds_read_b128 v[224:227], v245 offset:0
ds_read_b128 v[228:231], v245 offset:16896
ds_read_b128 v[232:235], v245 offset:32
ds_read_b128 v[236:239], v245 offset:16928
s_waitcnt lgkmcnt(3)
v_mfma_f32_32x32x16_bf16 v[144:159], v[224:227], v[4:7], 0
v_mfma_f32_32x32x16_bf16 v[128:143], v[224:227], v[0:3], 0
ds_read_b128 v[224:227], v245 offset:64
s_waitcnt lgkmcnt(3)
v_mfma_f32_32x32x16_bf16 v[208:223], v[228:231], v[4:7], 0
v_mfma_f32_32x32x16_bf16 v[192:207], v[228:231], v[0:3], 0
ds_read_b128 v[228:231], v245 offset:16960
s_waitcnt lgkmcnt(3)
v_mfma_f32_32x32x16_bf16 v[144:159], v[232:235], v[12:15], v[144:159]
ds_read_b32 v253, v248
v_mfma_f32_32x32x16_bf16 v[128:143], v[232:235], v[8:11], v[128:143]
ds_read_b128 v[232:235], v245 offset:96
s_waitcnt lgkmcnt(4)
v_mfma_f32_32x32x16_bf16 v[208:223], v[236:239], v[12:15], v[208:223]
v_mfma_f32_32x32x16_bf16 v[192:207], v[236:239], v[8:11], v[192:207]
ds_read_b128 v[236:239], v245 offset:16992
s_waitcnt lgkmcnt(4)
v_mfma_f32_32x32x16_bf16 v[144:159], v[224:227], v[20:23], v[144:159]
s_waitcnt lgkmcnt(2)
v_cmp_gt_u32 vcc, 25, v253
s_cbranch_vccnz L_waitQ25
L_goQ25:
v_mfma_f32_32x32x16_bf16 v[128:143], v[224:227], v[16:19], v[128:143]
ds_read_b128 v[224:227], v245 offset:128
v_mfma_f32_32x32x16_bf16 v[208:223], v[228:231], v[20:23], v[208:223]
s_add_u32 m0, s52, 0
s_add_u32 s31, s53, 65600
buffer_load_dwordx4 v250, s[16:19], s31 offen lds
v_mfma_f32_32x32x16_bf16 v[192:207], v[228:231], v[16:19], v[192:207]
ds_read_b128 v[228:231], v245 offset:17024
s_waitcnt lgkmcnt(3)
v_mfma_f32_32x32x16_bf16 v[144:159], v[232:235], v[28:31], v[144:159]
s_add_u32 m0, s52, 4096
s_add_u32 s31, s53, 73728
buffer_load_dwordx4 v250, s[16:19], s31 offen lds
v_mfma_f32_32x32x16_bf16 v[128:143], v[232:235], v[24:27], v[128:143]
ds_read_b128 v[232:235], v245 offset:160
s_waitcnt lgkmcnt(3)
v_mfma_f32_32x32x16_bf16 v[208:223], v[236:239], v[28:31], v[208:223]
s_add_u32 m0, s52, 8192
s_add_u32 s31, s53, 73792
buffer_load_dwordx4 v250, s[16:19], s31 offen lds
v_mfma_f32_32x32x16_bf16 v[192:207], v[236:239], v[24:27], v[192:207]
ds_read_b128 v[236:239], v245 offset:17056
s_waitcnt lgkmcnt(3)
v_mfma_f32_32x32x16_bf16 v[144:159], v[224:227], v[36:39], v[144:159]
s_add_u32 m0, s52, 12288
s_add_u32 s31, s53, 81920
buffer_load_dwordx4 v250, s[16:19], s31 offen lds
v_mfma_f32_32x32x16_bf16 v[128:143], v[224:227], v[32:35], v[128:143]
ds_read_b128 v[224:227], v245 offset:192
s_waitcnt lgkmcnt(3)
v_mfma_f32_32x32x16_bf16 v[208:223], v[228:231], v[36:39], v[208:223]
v_mfma_f32_32x32x16_bf16 v[192:207], v[228:231], v[32:35], v[192:207]
ds_read_b128 v[228:231], v245 offset:17088
s_waitcnt lgkmcnt(3)
v_mfma_f32_32x32x16_bf16 v[144:159], v[232:235], v[44:47], v[144:159]
s_add_u32 m0, s52, 16384
s_add_u32 s31, s53, 81984
buffer_load_dwordx4 v250, s[16:19], s31 offen lds
v_mfma_f32_32x32x16_bf16 v[128:143], v[232:235], v[40:43], v[128:143]
ds_read_b128 v[232:235], v245 offset:224
s_waitcnt lgkmcnt(3)
v_mfma_f32_32x32x16_bf16 v[208:223], v[236:239], v[44:47], v[208:223]
s_add_u32 m0, s52, 20480
s_add_u32 s31, s53, 90112
buffer_load_dwordx4 v250, s[16:19], s31 offen lds
v_mfma_f32_32x32x16_bf16 v[192:207], v[236:239], v[40:43], v[192:207]
ds_read_b128 v[236:239], v245 offset:17120
s_waitcnt lgkmcnt(3)
v_mfma_f32_32x32x16_bf16 v[144:159], v[224:227], v[52:55], v[144:159]
s_add_u32 m0, s52, 24576
s_add_u32 s31, s53, 90176
buffer_load_dwordx4 v250, s[16:19], s31 offen lds
v_mfma_f32_32x32x16_bf16 v[128:143], v[224:227], v[48:51], v[128:143]
ds_read_b128 v[224:227], v245 offset:256
s_waitcnt lgkmcnt(3)
v_mfma_f32_32x32x16_bf16 v[208:223], v[228:231], v[52:55], v[208:223]
s_add_u32 m0, s52, 28672
s_add_u32 s31, s53, 98304
buffer_load_dwordx4 v250, s[16:19], s31 offen lds
v_mfma_f32_32x32x16_bf16 v[192:207], v[228:231], v[48:51], v[192:207]
ds_read_b128 v[228:231], v245 offset:17152
s_waitcnt lgkmcnt(3)
v_mfma_f32_32x32x16_bf16 v[144:159], v[232:235], v[60:63], v[144:159]
v_mfma_f32_32x32x16_bf16 v[128:143], v[232:235], v[56:59], v[128:143]
ds_read_b128 v[232:235], v245 offset:288
s_waitcnt lgkmcnt(3)
v_mfma_f32_32x32x16_bf16 v[208:223], v[236:239], v[60:63], v[208:223]
s_add_u32 m0, s52, 32768
s_add_u32 s31, s53, 98368
buffer_load_dwordx4 v250, s[16:19], s31 offen lds
v_mfma_f32_32x32x16_bf16 v[192:207], v[236:239], v[56:59], v[192:207]
ds_read_b128 v[236:239], v245 offset:17184
s_waitcnt lgkmcnt(3)
v_mfma_f32_32x32x16_bf16 v[144:159], v[224:227], v[68:71], v[144:159]
s_add_u32 m0, s52, 36864
s_add_u32 s31, s53, 106496
buffer_load_dwordx4 v250, s[16:19], s31 offen lds
v_mfma_f32_32x32x16_bf16 v[128:143], v[224:227], v[64:67], v[128:143]
ds_read_b128 v[224:227], v245 offset:320
s_waitcnt lgkmcnt(3)
v_mfma_f32_32x32x16_bf16 v[208:223], v[228:231], v[68:71], v[208:223]
s_add_u32 m0, s52, 40960
s_add_u32 s31, s53, 106560
buffer_load_dwordx4 v250, s[16:19], s31 offen lds
v_mfma_f32_32x32x16_bf16 v[192:207], v[228:231], v[64:67], v[192:207]
ds_read_b128 v[228:231], v245 offset:17216
s_waitcnt lgkmcnt(3)
v_mfma_f32_32x32x16_bf16 v[144:159], v[232:235], v[76:79], v[144:159]
s_add_u32 m0, s52, 45056
s_add_u32 s31, s53, 114688
buffer_load_dwordx4 v250, s[16:19], s31 offen lds
v_mfma_f32_32x32x16_bf16 v[128:143], v[232:235], v[72:75], v[128:143]
ds_read_b128 v[232:235], v245 offset:352
s_waitcnt lgkmcnt(3)
v_mfma_f32_32x32x16_bf16 v[208:223], v[236:239], v[76:79], v[208:223]
v_mfma_f32_32x32x16_bf16 v[192:207], v[236:239], v[72:75], v[192:207]
ds_read_b128 v[236:239], v245 offset:17248
s_waitcnt lgkmcnt(3)
v_mfma_f32_32x32x16_bf16 v[144:159], v[224:227], v[84:87], v[144:159]
s_add_u32 m0, s52, 49152
s_add_u32 s31, s53, 114752
buffer_load_dwordx4 v250, s[16:19], s31 offen lds
v_mfma_f32_32x32x16_bf16 v[128:143], v[224:227], v[80:83], v[128:143]
ds_read_b128 v[224:227], v245 offset:384
s_waitcnt lgkmcnt(3)
v_mfma_f32_32x32x16_bf16 v[208:223], v[228:231], v[84:87], v[208:223]
s_add_u32 m0, s52, 53248
s_add_u32 s31, s53, 122880
buffer_load_dwordx4 v250, s[16:19], s31 offen lds
v_mfma_f32_32x32x16_bf16 v[192:207], v[228:231], v[80:83], v[192:207]
ds_read_b128 v[228:231], v245 offset:17280
s_waitcnt lgkmcnt(3)
v_mfma_f32_32x32x16_bf16 v[144:159], v[232:235], v[92:95], v[144:159]
s_add_u32 m0, s52, 57344
s_add_u32 s31, s53, 122944
buffer_load_dwordx4 v250, s[16:19], s31 offen lds
v_mfma_f32_32x32x16_bf16 v[128:143], v[232:235], v[88:91], v[128:143]
ds_read_b128 v[232:235], v245 offset:416
s_waitcnt lgkmcnt(3)
v_mfma_f32_32x32x16_bf16 v[208:223], v[236:239], v[92:95], v[208:223]
v_mfma_f32_32x32x16_bf16 v[192:207], v[236:239], v[88:91], v[192:207]
ds_read_b128 v[236:239], v245 offset:17312
s_waitcnt lgkmcnt(3)
v_mfma_f32_32x32x16_bf16 v[144:159], v[224:227], v[100:103], v[144:159]
v_mfma_f32_32x32x16_bf16 v[128:143], v[224:227], v[96:99], v[128:143]
ds_read_b128 v[224:227], v245 offset:448
s_waitcnt lgkmcnt(3)
v_mfma_f32_32x32x16_bf16 v[208:223], v[228:231], v[100:103], v[208:223]
v_mfma_f32_32x32x16_bf16 v[192:207], v[228:231], v[96:99], v[192:207]
ds_read_b128 v[228:231], v245 offset:17344
s_waitcnt lgkmcnt(3)
v_mfma_f32_32x32x16_bf16 v[144:159], v[232:235], v[108:111], v[144:159]
v_mfma_f32_32x32x16_bf16 v[128:143], v[232:235], v[104:107], v[128:143]
ds_read_b128 v[232:235], v245 offset:480
s_waitcnt lgkmcnt(3)
v_mfma_f32_32x32x16_bf16 v[208:223], v[236:239], v[108:111], v[208:223]
v_mfma_f32_32x32x16_bf16 v[192:207], v[236:239], v[104:107], v[192:207]
ds_read_b128 v[236:239], v245 offset:17376
s_waitcnt lgkmcnt(3)
v_mfma_f32_32x32x16_bf16 v[144:159], v[224:227], v[116:119], v[144:159]
v_mfma_f32_32x32x16_bf16 v[128:143], v[224:227], v[112:115], v[128:143]
s_waitcnt lgkmcnt(2)
v_mfma_f32_32x32x16_bf16 v[208:223], v[228:231], v[116:119], v[208:223]
v_mfma_f32_32x32x16_bf16 v[192:207], v[228:231], v[112:115], v[192:207]
s_waitcnt lgkmcnt(1)
v_mfma_f32_32x32x16_bf16 v[144:159], v[232:235], v[124:127], v[144:159]
v_mfma_f32_32x32x16_bf16 v[128:143], v[232:235], v[120:123], v[128:143]
s_waitcnt lgkmcnt(0)
v_mfma_f32_32x32x16_bf16 v[208:223], v[236:239], v[124:127], v[208:223]
v_mfma_f32_32x32x16_bf16 v[192:207], v[236:239], v[120:123], v[192:207]
s_waitcnt vmcnt(0)
v_mov_b32 v254, 30
ds_write_b32 v249, v254
v_exp_f32 v169, v185
v_exp_f32 v170, v186
v_exp_f32 v171, v187
v_exp_f32 v172, v188
v_exp_f32 v173, v189
v_exp_f32 v174, v190
v_exp_f32 v175, v191
v_fma_f32 v168, v168, s28, s28
v_fma_f32 v169, v169, s28, s28
v_fma_f32 v170, v170, s28, s28
v_fma_f32 v171, v171, s28, s28
v_fma_f32 v172, v172, s28, s28
v_fma_f32 v173, v173, s28, s28
v_fma_f32 v174, v174, s28, s28
v_fma_f32 v175, v175, s28, s28
v_rcp_f32 v168, v168
v_rcp_f32 v169, v169
v_rcp_f32 v170, v170
v_rcp_f32 v171, v171
v_rcp_f32 v172, v172
v_rcp_f32 v173, v173
v_rcp_f32 v174, v174
v_rcp_f32 v175, v175
v_mul_f32 v184, v184, v168
v_mul_f32 v185, v185, v169
v_mul_f32 v186, v186, v170
v_mul_f32 v187, v187, v171
v_mul_f32 v188, v188, v172
v_mul_f32 v189, v189, v173
v_mul_f32 v190, v190, v174
v_mul_f32 v191, v191, v175
v_cvt_pk_bf16_f32 v168, v184, v185
v_cvt_pk_bf16_f32 v169, v186, v187
v_cvt_pk_bf16_f32 v170, v188, v189
v_cvt_pk_bf16_f32 v171, v190, v191
ds_write_b128 v247, v[168:171] offset:50176
v_mov_b32 v254, 35
ds_write_b32 v249, v254
s_nop 3
v_mul_f32 v144, s28, v144
v_mul_f32 v145, s28, v145
v_mul_f32 v146, s28, v146
v_mul_f32 v147, s28, v147
v_mul_f32 v148, s28, v148
v_mul_f32 v149, s28, v149
v_mul_f32 v150, s28, v150
v_mul_f32 v151, s28, v151
v_mul_f32 v152, s28, v152
v_mul_f32 v153, s28, v153
v_mul_f32 v154, s28, v154
v_mul_f32 v155, s28, v155
v_mul_f32 v156, s28, v156
v_mul_f32 v157, s28, v157
v_mul_f32 v158, s28, v158
v_mul_f32 v159, s28, v159
v_exp_f32 v144, v144
v_exp_f32 v145, v145
v_exp_f32 v146, v146
v_exp_f32 v147, v147
v_exp_f32 v148, v148
v_exp_f32 v149, v149
v_exp_f32 v150, v150
v_exp_f32 v151, v151
v_exp_f32 v152, v152
v_exp_f32 v153, v153
v_exp_f32 v154, v154
v_exp_f32 v155, v155
v_exp_f32 v156, v156
v_exp_f32 v157, v157
v_exp_f32 v158, v158
v_exp_f32 v159, v159
v_fma_f32 v144, v144, v240, v240
v_fma_f32 v145, v145, v240, v240
v_fma_f32 v146, v146, v240, v240
v_fma_f32 v147, v147, v240, v240
v_fma_f32 v148, v148, v240, v240
v_fma_f32 v149, v149, v240, v240
v_fma_f32 v150, v150, v240, v240
v_fma_f32 v151, v151, v240, v240
v_fma_f32 v152, v152, v240, v240
v_fma_f32 v153, v153, v240, v240
v_fma_f32 v154, v154, v240, v240
v_fma_f32 v155, v155, v240, v240
v_fma_f32 v156, v156, v240, v240
v_fma_f32 v157, v157, v240, v240
v_fma_f32 v158, v158, v240, v240
v_fma_f32 v159, v159, v240, v240
v_rcp_f32 v144, v144
v_rcp_f32 v145, v145
v_rcp_f32 v146, v146
v_rcp_f32 v147, v147
v_rcp_f32 v148, v148
v_rcp_f32 v149, v149
v_rcp_f32 v150, v150
v_rcp_f32 v151, v151
v_rcp_f32 v152, v152
v_rcp_f32 v153, v153
v_rcp_f32 v154, v154
v_rcp_f32 v155, v155
v_rcp_f32 v156, v156
v_rcp_f32 v157, v157
v_rcp_f32 v158, v158
v_rcp_f32 v159, v159
v_mul_f32 v128, v128, v144
v_mul_f32 v129, v129, v145
v_mul_f32 v130, v130, v146
v_mul_f32 v131, v131, v147
v_mul_f32 v132, v132, v148
v_mul_f32 v133, v133, v149
v_mul_f32 v134, v134, v150
v_mul_f32 v135, v135, v151
v_mul_f32 v136, v136, v152
v_mul_f32 v137, v137, v153
v_mul_f32 v138, v138, v154
v_mul_f32 v139, v139, v155
v_mul_f32 v140, v140, v156
v_mul_f32 v141, v141, v157
v_mul_f32 v251, v142, v158
v_mul_f32 v252, v143, v159
v_fma_f32 v144, v242, v128, v244
v_fma_f32 v145, v242, v129, v128
v_fma_f32 v146, v242, v130, v129
v_fma_f32 v147, v242, v131, v130
v_fma_f32 v148, v242, v132, v131
v_fma_f32 v149, v242, v133, v132
v_fma_f32 v150, v242, v134, v133
v_fma_f32 v151, v242, v135, v134
v_fma_f32 v152, v242, v136, v135
v_fma_f32 v153, v242, v137, v136
v_fma_f32 v154, v242, v138, v137
v_fma_f32 v155, v242, v139, v138
v_fma_f32 v156, v242, v140, v139
v_fma_f32 v157, v242, v141, v140
v_fma_f32 v158, v242, v251, v141
v_fma_f32 v159, v242, v252, v251
v_fmac_f32 v144, v241, v243
v_fmac_f32 v145, v241, v244
v_fmac_f32 v146, v241, v128
v_fmac_f32 v147, v241, v129
v_fmac_f32 v148, v241, v130
v_fmac_f32 v149, v241, v131
v_fmac_f32 v150, v241, v132
v_fmac_f32 v151, v241, v133
v_fmac_f32 v152, v241, v134
v_fmac_f32 v153, v241, v135
v_fmac_f32 v154, v241, v136
v_fmac_f32 v155, v241, v137
v_fmac_f32 v156, v241, v138
v_fmac_f32 v157, v241, v139
v_fmac_f32 v158, v241, v140
v_fmac_f32 v159, v241, v141
v_exp_f32 v128, v144
v_exp_f32 v129, v145
v_exp_f32 v130, v146
v_exp_f32 v131, v147
v_exp_f32 v132, v148
v_exp_f32 v133, v149
v_exp_f32 v134, v150
v_exp_f32 v135, v151
v_fma_f32 v128, v128, s28, s28
v_fma_f32 v129, v129, s28, s28
v_fma_f32 v130, v130, s28, s28
v_fma_f32 v131, v131, s28, s28
v_fma_f32 v132, v132, s28, s28
v_fma_f32 v133, v133, s28, s28
v_fma_f32 v134, v134, s28, s28
v_fma_f32 v135, v135, s28, s28
v_rcp_f32 v128, v128
v_rcp_f32 v129, v129
v_rcp_f32 v130, v130
v_rcp_f32 v131, v131
v_rcp_f32 v132, v132
v_rcp_f32 v133, v133
v_rcp_f32 v134, v134
v_rcp_f32 v135, v135
v_mul_f32 v144, v144, v128
v_mul_f32 v145, v145, v129
v_mul_f32 v146, v146, v130
v_mul_f32 v147, v147, v131
v_mul_f32 v148, v148, v132
v_mul_f32 v149, v149, v133
v_mul_f32 v150, v150, v134
v_mul_f32 v151, v151, v135
v_cvt_pk_bf16_f32 v128, v144, v145
v_cvt_pk_bf16_f32 v129, v146, v147
v_cvt_pk_bf16_f32 v130, v148, v149
v_cvt_pk_bf16_f32 v131, v150, v151
ds_write_b128 v246, v[128:131] offset:0
v_exp_f32 v136, v152
v_exp_f32 v137, v153
v_exp_f32 v138, v154
v_exp_f32 v139, v155
v_exp_f32 v140, v156
v_exp_f32 v141, v157
v_exp_f32 v142, v158
v_exp_f32 v143, v159
v_fma_f32 v136, v136, s28, s28
v_fma_f32 v137, v137, s28, s28
v_fma_f32 v138, v138, s28, s28
v_fma_f32 v139, v139, s28, s28
v_fma_f32 v140, v140, s28, s28
v_fma_f32 v141, v141, s28, s28
v_fma_f32 v142, v142, s28, s28
v_fma_f32 v143, v143, s28, s28
v_rcp_f32 v136, v136
v_rcp_f32 v137, v137
v_rcp_f32 v138, v138
v_rcp_f32 v139, v139
v_rcp_f32 v140, v140
v_rcp_f32 v141, v141
v_rcp_f32 v142, v142
v_rcp_f32 v143, v143
v_mul_f32 v152, v152, v136
v_mul_f32 v153, v153, v137
v_mul_f32 v154, v154, v138
v_mul_f32 v155, v155, v139
v_mul_f32 v156, v156, v140
v_mul_f32 v157, v157, v141
v_mul_f32 v158, v158, v142
v_mul_f32 v159, v159, v143
v_cvt_pk_bf16_f32 v136, v152, v153
v_cvt_pk_bf16_f32 v137, v154, v155
v_cvt_pk_bf16_f32 v138, v156, v157
v_cvt_pk_bf16_f32 v139, v158, v159
ds_write_b128 v247, v[136:139] offset:0
v_mov_b32 v254, 40
ds_write_b32 v249, v254
v_mul_f32 v208, s28, v208
v_mul_f32 v209, s28, v209
v_mul_f32 v210, s28, v210
v_mul_f32 v211, s28, v211
v_mul_f32 v212, s28, v212
v_mul_f32 v213, s28, v213
v_mul_f32 v214, s28, v214
v_mul_f32 v215, s28, v215
v_mul_f32 v216, s28, v216
v_mul_f32 v217, s28, v217
v_mul_f32 v218, s28, v218
v_mul_f32 v219, s28, v219
v_mul_f32 v220, s28, v220
v_mul_f32 v221, s28, v221
v_mul_f32 v222, s28, v222
v_mul_f32 v223, s28, v223
v_exp_f32 v208, v208
v_exp_f32 v209, v209
v_exp_f32 v210, v210
v_exp_f32 v211, v211
v_exp_f32 v212, v212
v_exp_f32 v213, v213
v_exp_f32 v214, v214
v_exp_f32 v215, v215
v_exp_f32 v216, v216
v_exp_f32 v217, v217
v_exp_f32 v218, v218
v_exp_f32 v219, v219
v_exp_f32 v220, v220
v_exp_f32 v221, v221
v_exp_f32 v222, v222
v_exp_f32 v223, v223
v_fma_f32 v208, v208, v240, v240
v_fma_f32 v209, v209, v240, v240
v_fma_f32 v210, v210, v240, v240
v_fma_f32 v211, v211, v240, v240
v_fma_f32 v212, v212, v240, v240
v_fma_f32 v213, v213, v240, v240
v_fma_f32 v214, v214, v240, v240
v_fma_f32 v215, v215, v240, v240
v_fma_f32 v216, v216, v240, v240
v_fma_f32 v217, v217, v240, v240
v_fma_f32 v218, v218, v240, v240
v_fma_f32 v219, v219, v240, v240
v_fma_f32 v220, v220, v240, v240
v_fma_f32 v221, v221, v240, v240
v_fma_f32 v222, v222, v240, v240
v_fma_f32 v223, v223, v240, v240
v_rcp_f32 v208, v208
v_rcp_f32 v209, v209
v_rcp_f32 v210, v210
v_rcp_f32 v211, v211
v_rcp_f32 v212, v212
v_rcp_f32 v213, v213
v_rcp_f32 v214, v214
v_rcp_f32 v215, v215
v_rcp_f32 v216, v216
v_rcp_f32 v217, v217
v_rcp_f32 v218, v218
v_rcp_f32 v219, v219
v_rcp_f32 v220, v220
v_rcp_f32 v221, v221
v_rcp_f32 v222, v222
v_rcp_f32 v223, v223
v_mul_f32 v192, v192, v208
v_mul_f32 v193, v193, v209
v_mul_f32 v194, v194, v210
v_mul_f32 v195, v195, v211
v_mul_f32 v196, v196, v212
v_mul_f32 v197, v197, v213
v_mul_f32 v198, v198, v214
v_mul_f32 v199, v199, v215
v_mul_f32 v200, v200, v216
v_mul_f32 v201, v201, v217
v_mul_f32 v202, v202, v218
v_mul_f32 v203, v203, v219
v_mul_f32 v204, v204, v220
v_mul_f32 v205, v205, v221
v_mul_f32 v243, v206, v222
v_mul_f32 v244, v207, v223
v_fma_f32 v208, v242, v192, v252
v_fma_f32 v209, v242, v193, v192
v_fma_f32 v210, v242, v194, v193
v_fma_f32 v211, v242, v195, v194
v_fma_f32 v212, v242, v196, v195
v_fma_f32 v213, v242, v197, v196
v_fma_f32 v214, v242, v198, v197
v_fma_f32 v215, v242, v199, v198
v_fma_f32 v216, v242, v200, v199
v_fma_f32 v217, v242, v201, v200
v_fma_f32 v218, v242, v202, v201
v_fma_f32 v219, v242, v203, v202
v_fma_f32 v220, v242, v204, v203
v_fma_f32 v221, v242, v205, v204
v_fma_f32 v222, v242, v243, v205
v_fma_f32 v223, v242, v244, v243
v_fmac_f32 v208, v241, v251
v_fmac_f32 v209, v241, v252
v_fmac_f32 v210, v241, v192
v_fmac_f32 v211, v241, v193
v_fmac_f32 v212, v241, v194
v_fmac_f32 v213, v241, v195
v_fmac_f32 v214, v241, v196
v_fmac_f32 v215, v241, v197
v_fmac_f32 v216, v241, v198
v_fmac_f32 v217, v241, v199
v_fmac_f32 v218, v241, v200
v_fmac_f32 v219, v241, v201
v_fmac_f32 v220, v241, v202
v_fmac_f32 v221, v241, v203
v_fmac_f32 v222, v241, v204
v_fmac_f32 v223, v241, v205
v_exp_f32 v192, v208
v_exp_f32 v193, v209
v_exp_f32 v194, v210
v_exp_f32 v195, v211
v_exp_f32 v196, v212
v_exp_f32 v197, v213
v_exp_f32 v198, v214
v_exp_f32 v199, v215
v_fma_f32 v192, v192, s28, s28
v_fma_f32 v193, v193, s28, s28
v_fma_f32 v194, v194, s28, s28
v_fma_f32 v195, v195, s28, s28
v_fma_f32 v196, v196, s28, s28
v_fma_f32 v197, v197, s28, s28
v_fma_f32 v198, v198, s28, s28
v_fma_f32 v199, v199, s28, s28
v_rcp_f32 v192, v192
v_rcp_f32 v193, v193
v_rcp_f32 v194, v194
v_rcp_f32 v195, v195
v_rcp_f32 v196, v196
v_rcp_f32 v197, v197
v_rcp_f32 v198, v198
v_rcp_f32 v199, v199
v_mul_f32 v208, v208, v192
v_mul_f32 v209, v209, v193
v_mul_f32 v210, v210, v194
v_mul_f32 v211, v211, v195
v_mul_f32 v212, v212, v196
v_mul_f32 v213, v213, v197
v_mul_f32 v214, v214, v198
v_mul_f32 v215, v215, v199
v_cvt_pk_bf16_f32 v192, v208, v209
v_cvt_pk_bf16_f32 v193, v210, v211
v_cvt_pk_bf16_f32 v194, v212, v213
v_cvt_pk_bf16_f32 v195, v214, v215
ds_write_b128 v246, v[192:195] offset:16896
v_exp_f32 v200, v216
v_exp_f32 v201, v217
v_exp_f32 v202, v218
v_exp_f32 v203, v219
v_exp_f32 v204, v220
v_exp_f32 v205, v221
v_exp_f32 v206, v222
v_exp_f32 v207, v223
v_fma_f32 v200, v200, s28, s28
v_fma_f32 v201, v201, s28, s28
v_fma_f32 v202, v202, s28, s28
v_fma_f32 v203, v203, s28, s28
v_fma_f32 v204, v204, s28, s28
v_fma_f32 v205, v205, s28, s28
v_fma_f32 v206, v206, s28, s28
v_fma_f32 v207, v207, s28, s28
v_rcp_f32 v200, v200
v_rcp_f32 v201, v201
v_rcp_f32 v202, v202
v_rcp_f32 v203, v203
v_rcp_f32 v204, v204
v_rcp_f32 v205, v205
v_rcp_f32 v206, v206
v_rcp_f32 v207, v207
v_mul_f32 v216, v216, v200
v_mul_f32 v217, v217, v201
v_mul_f32 v218, v218, v202
v_mul_f32 v219, v219, v203
v_mul_f32 v220, v220, v204
v_mul_f32 v221, v221, v205
v_mul_f32 v222, v222, v206
v_mul_f32 v223, v223, v207
v_cvt_pk_bf16_f32 v200, v216, v217
v_cvt_pk_bf16_f32 v201, v218, v219
v_cvt_pk_bf16_f32 v202, v220, v221
v_cvt_pk_bf16_f32 v203, v222, v223
ds_write_b128 v247, v[200:203] offset:16896
v_mov_b32 v254, 50
ds_write_b32 v249, v254
s_endpgm
L_waitQh5:
ds_read_b32 v253, v248
s_waitcnt lgkmcnt(0)
v_cmp_gt_u32 vcc, 5, v253
s_cbranch_vccnz L_waitQh5
s_branch L_goQh5
L_waitQ20:
ds_read_b32 v253, v248
s_waitcnt lgkmcnt(0)
v_cmp_gt_u32 vcc, 20, v253
s_cbranch_vccnz L_waitQ20
s_branch L_goQ20
L_waitQ25:
ds_read_b32 v253, v248
s_waitcnt lgkmcnt(0)
v_cmp_gt_u32 vcc, 25, v253
s_cbranch_vccnz L_waitQ25
s_branch L_goQ25
L_slowP:
s_nop 4
v_mul_f32 v144, s28, v144
v_mul_f32 v145, s28, v145
v_mul_f32 v146, s28, v146
v_mul_f32 v147, s28, v147
v_mul_f32 v148, s28, v148
v_mul_f32 v149, s28, v149
v_mul_f32 v150, s28, v150
v_mul_f32 v151, s28, v151
v_mul_f32 v152, s28, v152
v_mul_f32 v153, s28, v153
v_mul_f32 v154, s28, v154
v_mul_f32 v155, s28, v155
v_mul_f32 v156, s28, v156
v_mul_f32 v157, s28, v157
v_mul_f32 v158, s28, v158
v_mul_f32 v159, s28, v159
v_exp_f32 v144, v144
v_exp_f32 v145, v145
v_exp_f32 v146, v146
v_exp_f32 v147, v147
v_exp_f32 v148, v148
v_exp_f32 v149, v149
v_exp_f32 v150, v150
v_exp_f32 v151, v151
v_exp_f32 v152, v152
v_exp_f32 v153, v153
v_exp_f32 v154, v154
v_exp_f32 v155, v155
v_exp_f32 v156, v156
v_exp_f32 v157, v157
v_exp_f32 v158, v158
v_exp_f32 v159, v159
v_add_f32 v144, 1.0, v144
v_add_f32 v145, 1.0, v145
v_add_f32 v146, 1.0, v146
v_add_f32 v147, 1.0, v147
v_add_f32 v148, 1.0, v148
v_add_f32 v149, 1.0, v149
v_add_f32 v150, 1.0, v150
v_add_f32 v151, 1.0, v151
v_add_f32 v152, 1.0, v152
v_add_f32 v153, 1.0, v153
v_add_f32 v154, 1.0, v154
v_add_f32 v155, 1.0, v155
v_add_f32 v156, 1.0, v156
v_add_f32 v157, 1.0, v157
v_add_f32 v158, 1.0, v158
v_add_f32 v159, 1.0, v159
v_rcp_f32 v144, v144
v_rcp_f32 v145, v145
v_rcp_f32 v146, v146
v_rcp_f32 v147, v147
v_rcp_f32 v148, v148
v_rcp_f32 v149, v149
v_rcp_f32 v150, v150
v_rcp_f32 v151, v151
v_rcp_f32 v152, v152
v_rcp_f32 v153, v153
v_rcp_f32 v154, v154
v_rcp_f32 v155, v155
v_rcp_f32 v156, v156
v_rcp_f32 v157, v157
v_rcp_f32 v158, v158
v_rcp_f32 v159, v159
v_mul_f32 v128, v128, v144
v_mul_f32 v129, v129, v145
v_mov_b32 v243, v128
v_mov_b32 v244, v128
v_cmp_gt_u32 vcc, 32, v255
v_mul_f32 v130, v130, v146
v_mul_f32 v131, v131, v147
v_mul_f32 v132, v132, v148
v_permlane32_swap_b32 v243, v244
v_mul_f32 v133, v133, v149
v_mul_f32 v134, v134, v150
v_mul_f32 v135, v135, v151
v_cndmask_b32 v244, v243, v244, vcc
v_mul_f32 v136, v136, v152
v_mul_f32 v137, v137, v153
v_mul_f32 v138, v138, v154
v_mul_f32 v139, v139, v155
v_mul_f32 v140, v140, v156
v_mul_f32 v141, v141, v157
v_mul_f32 v202, v142, v158
v_mul_f32 v203, v143, v159
v_mul_f32 v144, v240, v244
v_mul_f32 v145, v240, v128
v_mul_f32 v146, v240, v129
v_mul_f32 v147, v240, v130
v_mul_f32 v148, v240, v131
v_mul_f32 v149, v240, v132
v_mul_f32 v150, v240, v133
v_mul_f32 v151, v240, v134
v_mul_f32 v152, v240, v135
v_mul_f32 v153, v240, v136
v_mul_f32 v154, v240, v137
v_mul_f32 v155, v240, v138
v_mul_f32 v156, v240, v139
v_mul_f32 v157, v240, v140
v_mul_f32 v158, v240, v141
v_mul_f32 v159, v240, v202
v_fmac_f32 v144, v242, v128
v_fmac_f32 v145, v242, v129
v_fmac_f32 v146, v242, v130
v_fmac_f32 v147, v242, v131
v_fmac_f32 v148, v242, v132
v_fmac_f32 v149, v242, v133
v_fmac_f32 v150, v242, v134
v_fmac_f32 v151, v242, v135
v_fmac_f32 v152, v242, v136
v_fmac_f32 v153, v242, v137
v_fmac_f32 v154, v242, v138
v_fmac_f32 v155, v242, v139
v_fmac_f32 v156, v242, v140
v_fmac_f32 v157, v242, v141
v_fmac_f32 v158, v242, v202
v_fmac_f32 v159, v242, v203
v_fmac_f32 v144, v241, v243
v_fmac_f32 v145, v241, v244
v_fmac_f32 v146, v241, v128
v_fmac_f32 v147, v241, v129
v_fmac_f32 v148, v241, v130
v_fmac_f32 v149, v241, v131
v_fmac_f32 v150, v241, v132
v_fmac_f32 v151, v241, v133
v_fmac_f32 v152, v241, v134
v_fmac_f32 v153, v241, v135
v_fmac_f32 v154, v241, v136
v_fmac_f32 v155, v241, v137
v_fmac_f32 v156, v241, v138
v_fmac_f32 v157, v241, v139
v_fmac_f32 v158, v241, v140
v_fmac_f32 v159, v241, v141
v_exp_f32 v128, v144
v_exp_f32 v129, v145
v_exp_f32 v130, v146
v_exp_f32 v131, v147
v_exp_f32 v132, v148
v_exp_f32 v133, v149
v_exp_f32 v134, v150
v_exp_f32 v135, v151
v_fma_f32 v128, v128, s28, s28
v_fma_f32 v129, v129, s28, s28
v_fma_f32 v130, v130, s28, s28
v_fma_f32 v131, v131, s28, s28
v_fma_f32 v132, v132, s28, s28
v_fma_f32 v133, v133, s28, s28
v_fma_f32 v134, v134, s28, s28
v_fma_f32 v135, v135, s28, s28
v_rcp_f32 v128, v128
v_rcp_f32 v129, v129
v_rcp_f32 v130, v130
v_rcp_f32 v131, v131
v_rcp_f32 v132, v132
v_rcp_f32 v133, v133
v_rcp_f32 v134, v134
v_rcp_f32 v135, v135
v_mul_f32 v144, v144, v128
v_mul_f32 v145, v145, v129
v_mul_f32 v146, v146, v130
v_mul_f32 v147, v147, v131
v_mul_f32 v148, v148, v132
v_mul_f32 v149, v149, v133
v_mul_f32 v150, v150, v134
v_mul_f32 v151, v151, v135
v_cvt_pk_bf16_f32 v128, v144, v145
v_cvt_pk_bf16_f32 v129, v146, v147
v_cvt_pk_bf16_f32 v130, v148, v149
v_cvt_pk_bf16_f32 v131, v150, v151
ds_write_b128 v246, v[128:131] offset:33792
v_exp_f32 v136, v152
v_exp_f32 v137, v153
v_exp_f32 v138, v154
v_exp_f32 v139, v155
v_exp_f32 v140, v156
v_exp_f32 v141, v157
v_exp_f32 v142, v158
v_exp_f32 v143, v159
v_fma_f32 v136, v136, s28, s28
v_fma_f32 v137, v137, s28, s28
v_fma_f32 v138, v138, s28, s28
v_fma_f32 v139, v139, s28, s28
v_fma_f32 v140, v140, s28, s28
v_fma_f32 v141, v141, s28, s28
v_fma_f32 v142, v142, s28, s28
v_fma_f32 v143, v143, s28, s28
v_rcp_f32 v136, v136
v_rcp_f32 v137, v137
v_rcp_f32 v138, v138
v_rcp_f32 v139, v139
v_rcp_f32 v140, v140
v_rcp_f32 v141, v141
v_rcp_f32 v142, v142
v_rcp_f32 v143, v143
v_mul_f32 v152, v152, v136
v_mul_f32 v153, v153, v137
v_mul_f32 v154, v154, v138
v_mul_f32 v155, v155, v139
v_mul_f32 v156, v156, v140
v_mul_f32 v157, v157, v141
v_mul_f32 v158, v158, v142
v_mul_f32 v159, v159, v143
v_cvt_pk_bf16_f32 v136, v152, v153
v_cvt_pk_bf16_f32 v137, v154, v155
v_cvt_pk_bf16_f32 v138, v156, v157
v_cvt_pk_bf16_f32 v139, v158, v159
ds_write_b128 v247, v[136:139] offset:33792
ds_read_b32 v200, v198
v_mul_f32 v176, s28, v176
v_mul_f32 v177, s28, v177
v_mul_f32 v178, s28, v178
v_mul_f32 v179, s28, v179
v_mul_f32 v180, s28, v180
v_mul_f32 v181, s28, v181
v_mul_f32 v182, s28, v182
v_mul_f32 v183, s28, v183
v_mul_f32 v184, s28, v184
v_mul_f32 v185, s28, v185
v_mul_f32 v186, s28, v186
v_mul_f32 v187, s28, v187
v_mul_f32 v188, s28, v188
v_mul_f32 v189, s28, v189
v_mul_f32 v190, s28, v190
v_mul_f32 v191, s28, v191
v_exp_f32 v176, v176
v_exp_f32 v177, v177
v_exp_f32 v178, v178
v_exp_f32 v179, v179
s_waitcnt lgkmcnt(0)
v_cmp_gt_u32 vcc, 5, v200
s_cbranch_vccnz L_waitPs5
L_goPs5:
v_exp_f32 v180, v180
v_exp_f32 v181, v181
v_exp_f32 v182, v182
v_exp_f32 v183, v183
v_exp_f32 v184, v184
v_exp_f32 v185, v185
v_exp_f32 v186, v186
v_exp_f32 v187, v187
v_exp_f32 v188, v188
v_exp_f32 v189, v189
v_exp_f32 v190, v190
v_exp_f32 v191, v191
v_add_f32 v176, 1.0, v176
v_add_f32 v177, 1.0, v177
v_add_f32 v178, 1.0, v178
v_add_f32 v179, 1.0, v179
v_add_f32 v180, 1.0, v180
v_add_f32 v181, 1.0, v181
v_add_f32 v182, 1.0, v182
v_add_f32 v183, 1.0, v183
v_add_f32 v184, 1.0, v184
v_add_f32 v185, 1.0, v185
v_add_f32 v186, 1.0, v186
v_add_f32 v187, 1.0, v187
v_add_f32 v188, 1.0, v188
v_add_f32 v189, 1.0, v189
v_add_f32 v190, 1.0, v190
v_add_f32 v191, 1.0, v191
v_rcp_f32 v176, v176
v_rcp_f32 v177, v177
v_rcp_f32 v178, v178
v_rcp_f32 v179, v179
v_rcp_f32 v180, v180
v_rcp_f32 v181, v181
v_rcp_f32 v182, v182
v_rcp_f32 v183, v183
v_rcp_f32 v184, v184
v_rcp_f32 v185, v185
v_rcp_f32 v186, v186
v_rcp_f32 v187, v187
v_rcp_f32 v188, v188
v_rcp_f32 v189, v189
v_rcp_f32 v190, v190
v_rcp_f32 v191, v191
v_mul_f32 v160, v160, v176
v_mul_f32 v161, v161, v177
v_mul_f32 v162, v162, v178
v_mul_f32 v163, v163, v179
v_mul_f32 v164, v164, v180
v_mul_f32 v165, v165, v181
v_mul_f32 v166, v166, v182
v_mul_f32 v167, v167, v183
v_mul_f32 v168, v168, v184
v_mul_f32 v169, v169, v185
v_mul_f32 v170, v170, v186
v_mul_f32 v171, v171, v187
v_mul_f32 v172, v172, v188
v_mul_f32 v173, v173, v189
v_mul_f32 v243, v174, v190
v_mul_f32 v244, v175, v191
v_mul_f32 v176, v240, v203
v_mul_f32 v177, v240, v160
v_mul_f32 v178, v240, v161
v_mul_f32 v179, v240, v162
v_mul_f32 v180, v240, v163
v_mul_f32 v181, v240, v164
v_mul_f32 v182, v240, v165
v_mul_f32 v183, v240, v166
v_mul_f32 v184, v240, v167
v_mul_f32 v185, v240, v168
v_mul_f32 v186, v240, v169
v_mul_f32 v187, v240, v170
v_mul_f32 v188, v240, v171
v_mul_f32 v189, v240, v172
v_mul_f32 v190, v240, v173
v_mul_f32 v191, v240, v243
v_fmac_f32 v176, v242, v160
v_fmac_f32 v177, v242, v161
v_fmac_f32 v178, v242, v162
v_fmac_f32 v179, v242, v163
v_fmac_f32 v180, v242, v164
v_fmac_f32 v181, v242, v165
v_fmac_f32 v182, v242, v166
v_fmac_f32 v183, v242, v167
v_fmac_f32 v184, v242, v168
v_fmac_f32 v185, v242, v169
v_fmac_f32 v186, v242, v170
v_fmac_f32 v187, v242, v171
v_fmac_f32 v188, v242, v172
v_fmac_f32 v189, v242, v173
v_fmac_f32 v190, v242, v243
v_fmac_f32 v191, v242, v244
v_fmac_f32 v176, v241, v202
v_fmac_f32 v177, v241, v203
v_fmac_f32 v178, v241, v160
v_fmac_f32 v179, v241, v161
v_fmac_f32 v180, v241, v162
v_fmac_f32 v181, v241, v163
v_fmac_f32 v182, v241, v164
v_fmac_f32 v183, v241, v165
v_fmac_f32 v184, v241, v166
v_fmac_f32 v185, v241, v167
v_fmac_f32 v186, v241, v168
v_fmac_f32 v187, v241, v169
v_fmac_f32 v188, v241, v170
v_fmac_f32 v189, v241, v171
v_fmac_f32 v190, v241, v172
v_fmac_f32 v191, v241, v173
v_exp_f32 v160, v176
v_exp_f32 v161, v177
v_exp_f32 v162, v178
v_exp_f32 v163, v179
v_exp_f32 v164, v180
v_exp_f32 v165, v181
v_exp_f32 v166, v182
v_exp_f32 v167, v183
v_fma_f32 v160, v160, s28, s28
v_fma_f32 v161, v161, s28, s28
v_fma_f32 v162, v162, s28, s28
v_fma_f32 v163, v163, s28, s28
v_fma_f32 v164, v164, s28, s28
v_fma_f32 v165, v165, s28, s28
v_fma_f32 v166, v166, s28, s28
v_fma_f32 v167, v167, s28, s28
v_rcp_f32 v160, v160
v_rcp_f32 v161, v161
v_rcp_f32 v162, v162
v_rcp_f32 v163, v163
v_rcp_f32 v164, v164
v_rcp_f32 v165, v165
v_rcp_f32 v166, v166
v_rcp_f32 v167, v167
v_mul_f32 v176, v176, v160
v_mul_f32 v177, v177, v161
v_mul_f32 v178, v178, v162
v_mul_f32 v179, v179, v163
v_mul_f32 v180, v180, v164
v_mul_f32 v181, v181, v165
v_mul_f32 v182, v182, v166
v_mul_f32 v183, v183, v167
v_cvt_pk_bf16_f32 v160, v176, v177
v_cvt_pk_bf16_f32 v161, v178, v179
v_cvt_pk_bf16_f32 v162, v180, v181
v_cvt_pk_bf16_f32 v163, v182, v183
ds_write_b128 v246, v[160:163] offset:50176
v_exp_f32 v168, v184
v_exp_f32 v169, v185
v_exp_f32 v170, v186
v_exp_f32 v171, v187
v_exp_f32 v172, v188
v_exp_f32 v173, v189
v_exp_f32 v174, v190
v_exp_f32 v175, v191
v_fma_f32 v168, v168, s28, s28
v_fma_f32 v169, v169, s28, s28
v_fma_f32 v170, v170, s28, s28
v_fma_f32 v171, v171, s28, s28
v_fma_f32 v172, v172, s28, s28
v_fma_f32 v173, v173, s28, s28
v_fma_f32 v174, v174, s28, s28
v_fma_f32 v175, v175, s28, s28
v_rcp_f32 v168, v168
v_rcp_f32 v169, v169
v_rcp_f32 v170, v170
v_rcp_f32 v171, v171
v_rcp_f32 v172, v172
v_rcp_f32 v173, v173
v_rcp_f32 v174, v174
v_rcp_f32 v175, v175
v_mul_f32 v184, v184, v168
v_mul_f32 v185, v185, v169
v_mul_f32 v186, v186, v170
v_mul_f32 v187, v187, v171
v_mul_f32 v188, v188, v172
v_mul_f32 v189, v189, v173
v_mul_f32 v190, v190, v174
v_mul_f32 v191, v191, v175
v_cvt_pk_bf16_f32 v168, v184, v185
v_cvt_pk_bf16_f32 v169, v186, v187
v_cvt_pk_bf16_f32 v170, v188, v189
v_cvt_pk_bf16_f32 v171, v190, v191
ds_write_b128 v247, v[168:171] offset:50176
v_mov_b32 v201, 20
ds_write_b32 v199, v201
ds_read_b32 v200, v198
s_waitcnt lgkmcnt(0)
v_cmp_gt_u32 vcc, 10, v200
s_cbranch_vccnz L_waitPs10
L_goPs10:
v_add_u32 v245, 66560, v245
ds_read_b128 v[224:227], v245 offset:0
ds_read_b128 v[228:231], v245 offset:32
ds_read_b128 v[232:235], v245 offset:64
ds_read_b128 v[236:239], v245 offset:96
s_waitcnt lgkmcnt(3)
v_mfma_f32_32x32x16_bf16 v[144:159], v[224:227], v[4:7], 0
s_add_u32 m0, s52, 0
s_add_u32 s31, s53, 0
buffer_load_dwordx4 v192, s[16:19], s31 offen lds
v_mfma_f32_32x32x16_bf16 v[128:143], v[224:227], v[0:3], 0
ds_read_b128 v[224:227], v245 offset:128
s_waitcnt lgkmcnt(3)
v_mfma_f32_32x32x16_bf16 v[144:159], v[228:231], v[12:15], v[144:159]
s_add_u32 m0, s52, 4096
s_add_u32 s31, s53, 64
buffer_load_dwordx4 v192, s[16:19], s31 offen lds
v_mfma_f32_32x32x16_bf16 v[128:143], v[228:231], v[8:11], v[128:143]
ds_read_b128 v[228:231], v245 offset:160
s_waitcnt lgkmcnt(3)
v_mfma_f32_32x32x16_bf16 v[144:159], v[232:235], v[20:23], v[144:159]
v_mfma_f32_32x32x16_bf16 v[128:143], v[232:235], v[16:19], v[128:143]
ds_read_b128 v[232:235], v245 offset:192
s_add_u32 m0, s52, 8192
s_add_u32 s31, s53, 8192
buffer_load_dwordx4 v192, s[16:19], s31 offen lds
s_waitcnt lgkmcnt(3)
v_mfma_f32_32x32x16_bf16 v[144:159], v[236:239], v[28:31], v[144:159]
v_mfma_f32_32x32x16_bf16 v[128:143], v[236:239], v[24:27], v[128:143]
ds_read_b128 v[236:239], v245 offset:224
s_add_u32 m0, s52, 12288
s_add_u32 s31, s53, 8256
buffer_load_dwordx4 v192, s[16:19], s31 offen lds
s_waitcnt lgkmcnt(3)
v_mfma_f32_32x32x16_bf16 v[144:159], v[224:227], v[36:39], v[144:159]
v_mfma_f32_32x32x16_bf16 v[128:143], v[224:227], v[32:35], v[128:143]
ds_read_b128 v[224:227], v245 offset:256
s_waitcnt lgkmcnt(3)
v_mfma_f32_32x32x16_bf16 v[144:159], v[228:231], v[44:47], v[144:159]
s_add_u32 m0, s52, 16384
s_add_u32 s31, s53, 16384
buffer_load_dwordx4 v192, s[16:19], s31 offen lds
v_mfma_f32_32x32x16_bf16 v[128:143], v[228:231], v[40:43], v[128:143]
ds_read_b128 v[228:231], v245 offset:288
s_waitcnt lgkmcnt(3)
v_mfma_f32_32x32x16_bf16 v[144:159], v[232:235], v[52:55], v[144:159]
s_add_u32 m0, s52, 20480
s_add_u32 s31, s53, 16448
buffer_load_dwordx4 v192, s[16:19], s31 offen lds
v_mfma_f32_32x32x16_bf16 v[128:143], v[232:235], v[48:51], v[128:143]
ds_read_b128 v[232:235], v245 offset:320
s_waitcnt lgkmcnt(3)
v_mfma_f32_32x32x16_bf16 v[144:159], v[236:239], v[60:63], v[144:159]
v_mfma_f32_32x32x16_bf16 v[128:143], v[236:239], v[56:59], v[128:143]
ds_read_b128 v[236:239], v245 offset:352
s_add_u32 m0, s52, 24576
s_add_u32 s31, s53, 24576
buffer_load_dwordx4 v192, s[16:19], s31 offen lds
s_waitcnt lgkmcnt(3)
v_mfma_f32_32x32x16_bf16 v[144:159], v[224:227], v[68:71], v[144:159]
v_mfma_f32_32x32x16_bf16 v[128:143], v[224:227], v[64:67], v[128:143]
ds_read_b128 v[224:227], v245 offset:384
s_add_u32 m0, s52, 28672
s_add_u32 s31, s53, 24640
buffer_load_dwordx4 v192, s[16:19], s31 offen lds
s_waitcnt lgkmcnt(3)
v_mfma_f32_32x32x16_bf16 v[144:159], v[228:231], v[76:79], v[144:159]
v_mfma_f32_32x32x16_bf16 v[128:143], v[228:231], v[72:75], v[128:143]
ds_read_b128 v[228:231], v245 offset:416
s_waitcnt lgkmcnt(3)
v_mfma_f32_32x32x16_bf16 v[144:159], v[232:235], v[84:87], v[144:159]
s_add_u32 m0, s52, 32768
s_add_u32 s31, s53, 32768
buffer_load_dwordx4 v192, s[16:19], s31 offen lds
v_mfma_f32_32x32x16_bf16 v[128:143], v[232:235], v[80:83], v[128:143]
ds_read_b32 v200, v198
ds_read_b128 v[232:235], v245 offset:448
s_waitcnt lgkmcnt(4)
v_mfma_f32_32x32x16_bf16 v[144:159], v[236:239], v[92:95], v[144:159]
s_add_u32 m0, s52, 36864
s_add_u32 s31, s53, 32832
buffer_load_dwordx4 v192, s[16:19], s31 offen lds
v_mfma_f32_32x32x16_bf16 v[128:143], v[236:239], v[88:91], v[128:143]
ds_read_b128 v[236:239], v245 offset:480
s_waitcnt lgkmcnt(2)
v_cmp_gt_u32 vcc, 20, v200
s_cbranch_vccnz L_waitPs20
L_goPs20:
v_mfma_f32_32x32x16_bf16 v[144:159], v[224:227], v[100:103], v[144:159]
v_mfma_f32_32x32x16_bf16 v[128:143], v[224:227], v[96:99], v[128:143]
ds_read_b128 v[224:227], v245 offset:16896
s_add_u32 m0, s52, 40960
s_add_u32 s31, s53, 40960
buffer_load_dwordx4 v192, s[16:19], s31 offen lds
v_mfma_f32_32x32x16_bf16 v[144:159], v[228:231], v[108:111], v[144:159]
v_mfma_f32_32x32x16_bf16 v[128:143], v[228:231], v[104:107], v[128:143]
ds_read_b128 v[228:231], v245 offset:16928
s_add_u32 m0, s52, 45056
s_add_u32 s31, s53, 41024
buffer_load_dwordx4 v192, s[16:19], s31 offen lds
s_waitcnt lgkmcnt(3)
v_mfma_f32_32x32x16_bf16 v[144:159], v[232:235], v[116:119], v[144:159]
v_mfma_f32_32x32x16_bf16 v[128:143], v[232:235], v[112:115], v[128:143]
ds_read_b128 v[232:235], v245 offset:16960
s_waitcnt lgkmcnt(3)
v_mfma_f32_32x32x16_bf16 v[144:159], v[236:239], v[124:127], v[144:159]
s_add_u32 m0, s52, 49152
s_add_u32 s31, s53, 49152
buffer_load_dwordx4 v192, s[16:19], s31 offen lds
v_mfma_f32_32x32x16_bf16 v[128:143], v[236:239], v[120:123], v[128:143]
ds_read_b128 v[236:239], v245 offset:16992
s_waitcnt lgkmcnt(3)
v_mfma_f32_32x32x16_bf16 v[176:191], v[224:227], v[4:7], 0
s_add_u32 m0, s52, 53248
s_add_u32 s31, s53, 49216
buffer_load_dwordx4 v192, s[16:19], s31 offen lds
v_mfma_f32_32x32x16_bf16 v[160:175], v[224:227], v[0:3], 0
ds_read_b128 v[224:227], v245 offset:17024
s_waitcnt lgkmcnt(3)
v_mfma_f32_32x32x16_bf16 v[176:191], v[228:231], v[12:15], v[176:191]
s_waitcnt vmcnt(13)
ds_read_b64_tr_b16 v[0:1], v193 offset:0
ds_read_b64_tr_b16 v[2:3], v193 offset:512
v_mfma_f32_32x32x16_bf16 v[160:175], v[228:231], v[8:11], v[160:175]
ds_read_b128 v[228:231], v245 offset:17056
s_add_u32 m0, s52, 57344
s_add_u32 s31, s53, 57344
buffer_load_dwordx4 v192, s[16:19], s31 offen lds
s_waitcnt lgkmcnt(5)
v_mfma_f32_32x32x16_bf16 v[176:191], v[232:235], v[20:23], v[176:191]
s_waitcnt vmcnt(13)
ds_read_b64_tr_b16 v[4:5], v193 offset:4096
ds_read_b64_tr_b16 v[6:7], v193 offset:4608
v_mfma_f32_32x32x16_bf16 v[160:175], v[232:235], v[16:19], v[160:175]
ds_read_b128 v[232:235], v245 offset:17088
s_add_u32 m0, s52, -92160
s_add_u32 s31, s53, 57408
buffer_load_dwordx4 v192, s[16:19], s31 offen lds
s_waitcnt lgkmcnt(7)
v_mfma_f32_32x32x16_bf16 v[176:191], v[236:239], v[28:31], v[176:191]
s_waitcnt vmcnt(13)
ds_read_b64_tr_b16 v[8:9], v193 offset:8192
ds_read_b64_tr_b16 v[10:11], v193 offset:8704
v_mfma_f32_32x32x16_bf16 v[160:175], v[236:239], v[24:27], v[160:175]
ds_read_b128 v[236:239], v245 offset:17120
s_waitcnt vmcnt(12)
ds_read_b64_tr_b16 v[12:13], v193 offset:12288
s_waitcnt lgkmcnt(10)
v_mfma_f32_32x32x16_bf16 v[176:191], v[224:227], v[36:39], v[176:191]
s_add_u32 m0, s52, -88064
s_add_u32 s31, s53, 65536
buffer_load_dwordx4 v192, s[16:19], s31 offen lds
ds_read_b64_tr_b16 v[14:15], v193 offset:12800
v_mfma_f32_32x32x16_bf16 v[160:175], v[224:227], v[32:35], v[160:175]
ds_read_b128 v[224:227], v245 offset:17152
s_waitcnt vmcnt(12)
ds_read_b64_tr_b16 v[16:17], v193 offset:16384
s_waitcnt lgkmcnt(10)
v_mfma_f32_32x32x16_bf16 v[176:191], v[228:231], v[44:47], v[176:191]
ds_read_b64_tr_b16 v[18:19], v193 offset:16896
s_waitcnt vmcnt(11)
ds_read_b64_tr_b16 v[20:21], v193 offset:20480
v_mfma_f32_32x32x16_bf16 v[160:175], v[228:231], v[40:43], v[160:175]
ds_read_b128 v[228:231], v245 offset:17184
ds_read_b64_tr_b16 v[22:23], v193 offset:20992
s_waitcnt lgkmcnt(11)
v_mfma_f32_32x32x16_bf16 v[176:191], v[232:235], v[52:55], v[176:191]
s_waitcnt vmcnt(10)
ds_read_b64_tr_b16 v[24:25], v193 offset:24576
ds_read_b64_tr_b16 v[26:27], v193 offset:25088
v_mfma_f32_32x32x16_bf16 v[160:175], v[232:235], v[48:51], v[160:175]
ds_read_b128 v[232:235], v245 offset:17216
s_waitcnt vmcnt(9)
ds_read_b64_tr_b16 v[28:29], v193 offset:28672
s_waitcnt lgkmcnt(12)
v_mfma_f32_32x32x16_bf16 v[176:191], v[236:239], v[60:63], v[176:191]
ds_read_b64_tr_b16 v[30:31], v193 offset:29184
s_waitcnt vmcnt(8)
ds_read_b64_tr_b16 v[32:33], v193 offset:32768
v_mfma_f32_32x32x16_bf16 v[160:175], v[236:239], v[56:59], v[160:175]
ds_read_b128 v[236:239], v245 offset:17248
ds_read_b64_tr_b16 v[34:35], v193 offset:33280
s_waitcnt lgkmcnt(13)
v_mfma_f32_32x32x16_bf16 v[176:191], v[224:227], v[68:71], v[176:191]
s_waitcnt vmcnt(7)
ds_read_b64_tr_b16 v[36:37], v193 offset:36864
ds_read_b64_tr_b16 v[38:39], v193 offset:37376
v_mfma_f32_32x32x16_bf16 v[160:175], v[224:227], v[64:67], v[160:175]
ds_read_b128 v[224:227], v245 offset:17280
s_waitcnt vmcnt(6)
ds_read_b64_tr_b16 v[40:41], v193 offset:40960
s_waitcnt lgkmcnt(13)
v_mfma_f32_32x32x16_bf16 v[176:191], v[228:231], v[76:79], v[176:191]
ds_read_b64_tr_b16 v[42:43], v193 offset:41472
s_waitcnt vmcnt(5)
ds_read_b64_tr_b16 v[44:45], v193 offset:45056
v_mfma_f32_32x32x16_bf16 v[160:175], v[228:231], v[72:75], v[160:175]
ds_read_b128 v[228:231], v245 offset:17312
ds_read_b64_tr_b16 v[46:47], v193 offset:45568
s_waitcnt lgkmcnt(13)
v_mfma_f32_32x32x16_bf16 v[176:191], v[232:235], v[84:87], v[176:191]
s_waitcnt vmcnt(4)
ds_read_b64_tr_b16 v[48:49], v193 offset:49152
ds_read_b64_tr_b16 v[50:51], v193 offset:49664
v_mfma_f32_32x32x16_bf16 v[160:175], v[232:235], v[80:83], v[160:175]
ds_read_b128 v[232:235], v245 offset:17344
s_waitcnt vmcnt(3)
ds_read_b64_tr_b16 v[52:53], v193 offset:53248
s_waitcnt lgkmcnt(13)
v_mfma_f32_32x32x16_bf16 v[176:191], v[236:239], v[92:95], v[176:191]
ds_read_b64_tr_b16 v[54:55], v193 offset:53760
v_mfma_f32_32x32x16_bf16 v[160:175], v[236:239], v[88:91], v[160:175]
ds_read_b128 v[236:239], v245 offset:17376
s_waitcnt vmcnt(2)
ds_read_b64_tr_b16 v[56:57], v193 offset:57344
s_waitcnt lgkmcnt(12)
v_mfma_f32_32x32x16_bf16 v[176:191], v[224:227], v[100:103], v[176:191]
ds_read_b64_tr_b16 v[58:59], v193 offset:57856
s_waitcnt vmcnt(1)
ds_read_b64_tr_b16 v[60:61], v204 offset:0
v_mfma_f32_32x32x16_bf16 v[160:175], v[224:227], v[96:99], v[160:175]
ds_read_b64_tr_b16 v[62:63], v204 offset:512
s_waitcnt lgkmcnt(11)
v_mfma_f32_32x32x16_bf16 v[176:191], v[228:231], v[108:111], v[176:191]
s_waitcnt vmcnt(0)
ds_read_b64_tr_b16 v[64:65], v204 offset:4096
ds_read_b64_tr_b16 v[66:67], v204 offset:4608
v_mfma_f32_32x32x16_bf16 v[160:175], v[228:231], v[104:107], v[160:175]
s_waitcnt lgkmcnt(9)
v_mfma_f32_32x32x16_bf16 v[176:191], v[232:235], v[116:119], v[176:191]
v_mfma_f32_32x32x16_bf16 v[160:175], v[232:235], v[112:115], v[160:175]
s_waitcnt lgkmcnt(6)
v_mfma_f32_32x32x16_bf16 v[176:191], v[236:239], v[124:127], v[176:191]
v_mfma_f32_32x32x16_bf16 v[160:175], v[236:239], v[120:123], v[160:175]
v_mov_b32 v201, 25
ds_write_b32 v199, v201
v_mul_f32 v144, s28, v144
v_mul_f32 v145, s28, v145
v_mul_f32 v146, s28, v146
v_mul_f32 v147, s28, v147
v_mul_f32 v148, s28, v148
v_mul_f32 v149, s28, v149
v_mul_f32 v150, s28, v150
v_mul_f32 v151, s28, v151
v_mul_f32 v152, s28, v152
v_mul_f32 v153, s28, v153
v_mul_f32 v154, s28, v154
v_mul_f32 v155, s28, v155
v_mul_f32 v156, s28, v156
v_mul_f32 v157, s28, v157
v_mul_f32 v158, s28, v158
v_mul_f32 v159, s28, v159
v_exp_f32 v144, v144
v_exp_f32 v145, v145
v_exp_f32 v146, v146
v_exp_f32 v147, v147
v_exp_f32 v148, v148
v_exp_f32 v149, v149
v_exp_f32 v150, v150
v_exp_f32 v151, v151
v_exp_f32 v152, v152
v_exp_f32 v153, v153
v_exp_f32 v154, v154
v_exp_f32 v155, v155
v_exp_f32 v156, v156
v_exp_f32 v157, v157
v_exp_f32 v158, v158
v_exp_f32 v159, v159
v_add_f32 v144, 1.0, v144
v_add_f32 v145, 1.0, v145
v_add_f32 v146, 1.0, v146
v_add_f32 v147, 1.0, v147
v_add_f32 v148, 1.0, v148
v_add_f32 v149, 1.0, v149
v_add_f32 v150, 1.0, v150
v_add_f32 v151, 1.0, v151
v_add_f32 v152, 1.0, v152
v_add_f32 v153, 1.0, v153
v_add_f32 v154, 1.0, v154
v_add_f32 v155, 1.0, v155
v_add_f32 v156, 1.0, v156
v_add_f32 v157, 1.0, v157
v_add_f32 v158, 1.0, v158
v_add_f32 v159, 1.0, v159
v_rcp_f32 v144, v144
v_rcp_f32 v145, v145
v_rcp_f32 v146, v146
v_rcp_f32 v147, v147
v_rcp_f32 v148, v148
v_rcp_f32 v149, v149
v_rcp_f32 v150, v150
v_rcp_f32 v151, v151
v_rcp_f32 v152, v152
v_rcp_f32 v153, v153
v_rcp_f32 v154, v154
v_rcp_f32 v155, v155
v_rcp_f32 v156, v156
v_rcp_f32 v157, v157
v_rcp_f32 v158, v158
v_rcp_f32 v159, v159
v_mul_f32 v128, v128, v144
v_mul_f32 v129, v129, v145
v_mul_f32 v130, v130, v146
v_mul_f32 v131, v131, v147
v_mul_f32 v132, v132, v148
v_mul_f32 v133, v133, v149
v_mul_f32 v134, v134, v150
v_mul_f32 v135, v135, v151
v_mul_f32 v136, v136, v152
v_mul_f32 v137, v137, v153
v_mul_f32 v138, v138, v154
v_mul_f32 v139, v139, v155
v_mul_f32 v140, v140, v156
v_mul_f32 v141, v141, v157
v_mul_f32 v202, v142, v158
v_mul_f32 v203, v143, v159
v_mul_f32 v144, v240, v244
v_mul_f32 v145, v240, v128
v_mul_f32 v146, v240, v129
v_mul_f32 v147, v240, v130
v_mul_f32 v148, v240, v131
v_mul_f32 v149, v240, v132
v_mul_f32 v150, v240, v133
v_mul_f32 v151, v240, v134
v_mul_f32 v152, v240, v135
v_mul_f32 v153, v240, v136
v_mul_f32 v154, v240, v137
v_mul_f32 v155, v240, v138
v_mul_f32 v156, v240, v139
v_mul_f32 v157, v240, v140
v_mul_f32 v158, v240, v141
v_mul_f32 v159, v240, v202
v_fmac_f32 v144, v242, v128
v_fmac_f32 v145, v242, v129
v_fmac_f32 v146, v242, v130
v_fmac_f32 v147, v242, v131
v_fmac_f32 v148, v242, v132
v_fmac_f32 v149, v242, v133
v_fmac_f32 v150, v242, v134
v_fmac_f32 v151, v242, v135
v_fmac_f32 v152, v242, v136
v_fmac_f32 v153, v242, v137
v_fmac_f32 v154, v242, v138
v_fmac_f32 v155, v242, v139
v_fmac_f32 v156, v242, v140
v_fmac_f32 v157, v242, v141
v_fmac_f32 v158, v242, v202
v_fmac_f32 v159, v242, v203
v_fmac_f32 v144, v241, v243
v_fmac_f32 v145, v241, v244
v_fmac_f32 v146, v241, v128
v_fmac_f32 v147, v241, v129
v_fmac_f32 v148, v241, v130
v_fmac_f32 v149, v241, v131
v_fmac_f32 v150, v241, v132
v_fmac_f32 v151, v241, v133
v_fmac_f32 v152, v241, v134
v_fmac_f32 v153, v241, v135
v_fmac_f32 v154, v241, v136
v_fmac_f32 v155, v241, v137
v_fmac_f32 v156, v241, v138
v_fmac_f32 v157, v241, v139
v_fmac_f32 v158, v241, v140
v_fmac_f32 v159, v241, v141
v_exp_f32 v128, v144
v_exp_f32 v129, v145
v_exp_f32 v130, v146
v_exp_f32 v131, v147
v_exp_f32 v132, v148
v_exp_f32 v133, v149
v_exp_f32 v134, v150
v_exp_f32 v135, v151
v_fma_f32 v128, v128, s28, s28
v_fma_f32 v129, v129, s28, s28
v_fma_f32 v130, v130, s28, s28
v_fma_f32 v131, v131, s28, s28
v_fma_f32 v132, v132, s28, s28
v_fma_f32 v133, v133, s28, s28
v_fma_f32 v134, v134, s28, s28
v_fma_f32 v135, v135, s28, s28
v_rcp_f32 v128, v128
v_rcp_f32 v129, v129
v_rcp_f32 v130, v130
v_rcp_f32 v131, v131
v_rcp_f32 v132, v132
v_rcp_f32 v133, v133
v_rcp_f32 v134, v134
v_rcp_f32 v135, v135
v_mul_f32 v144, v144, v128
v_mul_f32 v145, v145, v129
v_mul_f32 v146, v146, v130
v_mul_f32 v147, v147, v131
v_mul_f32 v148, v148, v132
v_mul_f32 v149, v149, v133
v_mul_f32 v150, v150, v134
v_mul_f32 v151, v151, v135
v_cvt_pk_bf16_f32 v128, v144, v145
v_cvt_pk_bf16_f32 v129, v146, v147
v_cvt_pk_bf16_f32 v130, v148, v149
v_cvt_pk_bf16_f32 v131, v150, v151
ds_write_b128 v246, v[128:131] offset:0
v_exp_f32 v136, v152
v_exp_f32 v137, v153
v_exp_f32 v138, v154
v_exp_f32 v139, v155
v_exp_f32 v140, v156
v_exp_f32 v141, v157
v_exp_f32 v142, v158
v_exp_f32 v143, v159
v_fma_f32 v136, v136, s28, s28
v_fma_f32 v137, v137, s28, s28
v_fma_f32 v138, v138, s28, s28
v_fma_f32 v139, v139, s28, s28
v_fma_f32 v140, v140, s28, s28
v_fma_f32 v141, v141, s28, s28
v_fma_f32 v142, v142, s28, s28
v_fma_f32 v143, v143, s28, s28
v_rcp_f32 v136, v136
v_rcp_f32 v137, v137
v_rcp_f32 v138, v138
v_rcp_f32 v139, v139
v_rcp_f32 v140, v140
v_rcp_f32 v141, v141
v_rcp_f32 v142, v142
v_rcp_f32 v143, v143
v_mul_f32 v152, v152, v136
v_mul_f32 v153, v153, v137
v_mul_f32 v154, v154, v138
v_mul_f32 v155, v155, v139
v_mul_f32 v156, v156, v140
v_mul_f32 v157, v157, v141
v_mul_f32 v158, v158, v142
v_mul_f32 v159, v159, v143
v_cvt_pk_bf16_f32 v136, v152, v153
v_cvt_pk_bf16_f32 v137, v154, v155
v_cvt_pk_bf16_f32 v138, v156, v157
v_cvt_pk_bf16_f32 v139, v158, v159
ds_write_b128 v247, v[136:139] offset:0
v_mul_f32 v176, s28, v176
v_mul_f32 v177, s28, v177
v_mul_f32 v178, s28, v178
v_mul_f32 v179, s28, v179
v_mul_f32 v180, s28, v180
v_mul_f32 v181, s28, v181
v_mul_f32 v182, s28, v182
v_mul_f32 v183, s28, v183
v_mul_f32 v184, s28, v184
v_mul_f32 v185, s28, v185
v_mul_f32 v186, s28, v186
v_mul_f32 v187, s28, v187
v_mul_f32 v188, s28, v188
v_mul_f32 v189, s28, v189
v_mul_f32 v190, s28, v190
v_mul_f32 v191, s28, v191
v_exp_f32 v176, v176
v_exp_f32 v177, v177
v_exp_f32 v178, v178
v_exp_f32 v179, v179
v_mov_b32 v201, 30
ds_write_b32 v199, v201
v_exp_f32 v180, v180
v_exp_f32 v181, v181
v_exp_f32 v182, v182
v_exp_f32 v183, v183
v_exp_f32 v184, v184
v_exp_f32 v185, v185
v_exp_f32 v186, v186
v_exp_f32 v187, v187
v_exp_f32 v188, v188
v_exp_f32 v189, v189
v_exp_f32 v190, v190
v_exp_f32 v191, v191
v_add_f32 v176, 1.0, v176
v_add_f32 v177, 1.0, v177
v_add_f32 v178, 1.0, v178
v_add_f32 v179, 1.0, v179
v_add_f32 v180, 1.0, v180
v_add_f32 v181, 1.0, v181
v_add_f32 v182, 1.0, v182
v_add_f32 v183, 1.0, v183
v_add_f32 v184, 1.0, v184
v_add_f32 v185, 1.0, v185
v_add_f32 v186, 1.0, v186
v_add_f32 v187, 1.0, v187
v_add_f32 v188, 1.0, v188
v_add_f32 v189, 1.0, v189
v_add_f32 v190, 1.0, v190
v_add_f32 v191, 1.0, v191
v_rcp_f32 v176, v176
v_rcp_f32 v177, v177
v_rcp_f32 v178, v178
v_rcp_f32 v179, v179
v_rcp_f32 v180, v180
v_rcp_f32 v181, v181
v_rcp_f32 v182, v182
v_rcp_f32 v183, v183
v_rcp_f32 v184, v184
v_rcp_f32 v185, v185
v_rcp_f32 v186, v186
v_rcp_f32 v187, v187
v_rcp_f32 v188, v188
v_rcp_f32 v189, v189
v_rcp_f32 v190, v190
v_rcp_f32 v191, v191
v_mul_f32 v160, v160, v176
v_mul_f32 v161, v161, v177
v_mul_f32 v162, v162, v178
v_mul_f32 v163, v163, v179
v_mul_f32 v164, v164, v180
v_mul_f32 v165, v165, v181
v_mul_f32 v166, v166, v182
v_mul_f32 v167, v167, v183
v_mul_f32 v168, v168, v184
v_mul_f32 v169, v169, v185
v_mul_f32 v170, v170, v186
v_mul_f32 v171, v171, v187
v_mul_f32 v172, v172, v188
v_mul_f32 v173, v173, v189
v_mul_f32 v243, v174, v190
v_mul_f32 v244, v175, v191
v_mul_f32 v176, v240, v203
v_mul_f32 v177, v240, v160
v_mul_f32 v178, v240, v161
v_mul_f32 v179, v240, v162
v_mul_f32 v180, v240, v163
v_mul_f32 v181, v240, v164
v_mul_f32 v182, v240, v165
v_mul_f32 v183, v240, v166
v_mul_f32 v184, v240, v167
v_mul_f32 v185, v240, v168
v_mul_f32 v186, v240, v169
v_mul_f32 v187, v240, v170
v_mul_f32 v188, v240, v171
v_mul_f32 v189, v240, v172
v_mul_f32 v190, v240, v173
v_mul_f32 v191, v240, v243
v_fmac_f32 v176, v242, v160
v_fmac_f32 v177, v242, v161
v_fmac_f32 v178, v242, v162
v_fmac_f32 v179, v242, v163
v_fmac_f32 v180, v242, v164
v_fmac_f32 v181, v242, v165
v_fmac_f32 v182, v242, v166
v_fmac_f32 v183, v242, v167
v_fmac_f32 v184, v242, v168
v_fmac_f32 v185, v242, v169
v_fmac_f32 v186, v242, v170
v_fmac_f32 v187, v242, v171
v_fmac_f32 v188, v242, v172
v_fmac_f32 v189, v242, v173
v_fmac_f32 v190, v242, v243
v_fmac_f32 v191, v242, v244
v_fmac_f32 v176, v241, v202
v_fmac_f32 v177, v241, v203
v_fmac_f32 v178, v241, v160
v_fmac_f32 v179, v241, v161
v_fmac_f32 v180, v241, v162
v_fmac_f32 v181, v241, v163
v_fmac_f32 v182, v241, v164
v_fmac_f32 v183, v241, v165
v_fmac_f32 v184, v241, v166
v_fmac_f32 v185, v241, v167
v_fmac_f32 v186, v241, v168
v_fmac_f32 v187, v241, v169
v_fmac_f32 v188, v241, v170
v_fmac_f32 v189, v241, v171
v_fmac_f32 v190, v241, v172
v_fmac_f32 v191, v241, v173
v_exp_f32 v160, v176
v_exp_f32 v161, v177
v_exp_f32 v162, v178
v_exp_f32 v163, v179
v_exp_f32 v164, v180
v_exp_f32 v165, v181
v_exp_f32 v166, v182
v_exp_f32 v167, v183
v_fma_f32 v160, v160, s28, s28
v_fma_f32 v161, v161, s28, s28
v_fma_f32 v162, v162, s28, s28
v_fma_f32 v163, v163, s28, s28
v_fma_f32 v164, v164, s28, s28
v_fma_f32 v165, v165, s28, s28
v_fma_f32 v166, v166, s28, s28
v_fma_f32 v167, v167, s28, s28
v_rcp_f32 v160, v160
v_rcp_f32 v161, v161
v_rcp_f32 v162, v162
v_rcp_f32 v163, v163
v_rcp_f32 v164, v164
v_rcp_f32 v165, v165
v_rcp_f32 v166, v166
v_rcp_f32 v167, v167
v_mul_f32 v176, v176, v160
v_mul_f32 v177, v177, v161
v_mul_f32 v178, v178, v162
v_mul_f32 v179, v179, v163
v_mul_f32 v180, v180, v164
v_mul_f32 v181, v181, v165
v_mul_f32 v182, v182, v166
v_mul_f32 v183, v183, v167
v_cvt_pk_bf16_f32 v160, v176, v177
v_cvt_pk_bf16_f32 v161, v178, v179
v_cvt_pk_bf16_f32 v162, v180, v181
v_cvt_pk_bf16_f32 v163, v182, v183
ds_write_b128 v246, v[160:163] offset:16896
v_exp_f32 v168, v184
v_exp_f32 v169, v185
v_exp_f32 v170, v186
v_exp_f32 v171, v187
v_exp_f32 v172, v188
v_exp_f32 v173, v189
ds_read_b32 v200, v198
v_exp_f32 v174, v190
v_exp_f32 v175, v191
v_fma_f32 v168, v168, s28, s28
v_fma_f32 v169, v169, s28, s28
v_fma_f32 v170, v170, s28, s28
v_fma_f32 v171, v171, s28, s28
v_fma_f32 v172, v172, s28, s28
v_fma_f32 v173, v173, s28, s28
v_fma_f32 v174, v174, s28, s28
v_fma_f32 v175, v175, s28, s28
v_rcp_f32 v168, v168
v_rcp_f32 v169, v169
v_rcp_f32 v170, v170
v_rcp_f32 v171, v171
v_rcp_f32 v172, v172
s_waitcnt lgkmcnt(0)
v_cmp_gt_u32 vcc, 30, v200
s_cbranch_vccnz L_waitPs30
L_goPs30:
ds_read_b64_tr_b16 v[208:209], v248 offset:33792
ds_read_b64_tr_b16 v[210:211], v248 offset:34304
ds_read_b64_tr_b16 v[212:213], v248 offset:34816
ds_read_b64_tr_b16 v[214:215], v248 offset:35328
ds_read_b64_tr_b16 v[216:217], v248 offset:35840
ds_read_b64_tr_b16 v[218:219], v248 offset:36352
ds_read_b64_tr_b16 v[220:221], v248 offset:36864
ds_read_b64_tr_b16 v[222:223], v248 offset:37376
v_rcp_f32 v173, v173
v_rcp_f32 v174, v174
v_rcp_f32 v175, v175
v_mul_f32 v184, v184, v168
v_mul_f32 v185, v185, v169
v_mul_f32 v186, v186, v170
v_mul_f32 v187, v187, v171
v_mul_f32 v188, v188, v172
v_mul_f32 v189, v189, v173
v_mul_f32 v190, v190, v174
v_mul_f32 v191, v191, v175
s_waitcnt lgkmcnt(6)
v_mfma_f32_32x32x16_bf16 v[128:143], v[0:3], v[208:211], 0
ds_read_b64_tr_b16 v[68:69], v193 offset:0
ds_read_b64_tr_b16 v[70:71], v193 offset:512
v_cvt_pk_bf16_f32 v168, v184, v185
v_cvt_pk_bf16_f32 v169, v186, v187
v_cvt_pk_bf16_f32 v170, v188, v189
v_cvt_pk_bf16_f32 v171, v190, v191
ds_write_b128 v247, v[168:171] offset:16896
v_mov_b32 v201, 60
ds_write_b32 v199, v201
v_mfma_f32_32x32x16_bf16 v[144:159], v[4:7], v[208:211], 0
ds_read_b64_tr_b16 v[208:209], v248 offset:37888
s_waitcnt lgkmcnt(9)
v_mfma_f32_32x32x16_bf16 v[128:143], v[8:11], v[212:215], v[128:143]
ds_read_b64_tr_b16 v[210:211], v248 offset:38400
ds_read_b64_tr_b16 v[72:73], v193 offset:4096
v_mfma_f32_32x32x16_bf16 v[144:159], v[12:15], v[212:215], v[144:159]
ds_read_b64_tr_b16 v[212:213], v248 offset:38912
ds_read_b64_tr_b16 v[74:75], v193 offset:4608
s_waitcnt lgkmcnt(11)
v_mfma_f32_32x32x16_bf16 v[128:143], v[16:19], v[216:219], v[128:143]
ds_read_b64_tr_b16 v[214:215], v248 offset:39424
ds_read_b64_tr_b16 v[76:77], v193 offset:8192
v_mfma_f32_32x32x16_bf16 v[144:159], v[20:23], v[216:219], v[144:159]
ds_read_b64_tr_b16 v[216:217], v248 offset:39936
ds_read_b64_tr_b16 v[78:79], v193 offset:8704
s_waitcnt lgkmcnt(13)
v_mfma_f32_32x32x16_bf16 v[128:143], v[24:27], v[220:223], v[128:143]
ds_read_b64_tr_b16 v[218:219], v248 offset:40448
ds_read_b64_tr_b16 v[80:81], v193 offset:12288
v_mfma_f32_32x32x16_bf16 v[144:159], v[28:31], v[220:223], v[144:159]
ds_read_b64_tr_b16 v[220:221], v248 offset:40960
ds_read_b64_tr_b16 v[82:83], v193 offset:12800
s_waitcnt lgkmcnt(11)
v_mfma_f32_32x32x16_bf16 v[128:143], v[32:35], v[208:211], v[128:143]
ds_read_b64_tr_b16 v[222:223], v248 offset:41472
ds_read_b64_tr_b16 v[84:85], v193 offset:16384
v_mfma_f32_32x32x16_bf16 v[144:159], v[36:39], v[208:211], v[144:159]
ds_read_b64_tr_b16 v[208:209], v248 offset:41984
ds_read_b64_tr_b16 v[86:87], v193 offset:16896
s_waitcnt lgkmcnt(11)
v_mfma_f32_32x32x16_bf16 v[128:143], v[40:43], v[212:215], v[128:143]
ds_read_b64_tr_b16 v[210:211], v248 offset:42496
ds_read_b64_tr_b16 v[88:89], v193 offset:20480
v_mfma_f32_32x32x16_bf16 v[144:159], v[44:47], v[212:215], v[144:159]
ds_read_b64_tr_b16 v[212:213], v248 offset:43008
ds_read_b64_tr_b16 v[90:91], v193 offset:20992
s_waitcnt lgkmcnt(11)
v_mfma_f32_32x32x16_bf16 v[128:143], v[48:51], v[216:219], v[128:143]
ds_read_b64_tr_b16 v[214:215], v248 offset:43520
ds_read_b64_tr_b16 v[92:93], v193 offset:24576
v_mfma_f32_32x32x16_bf16 v[144:159], v[52:55], v[216:219], v[144:159]
ds_read_b64_tr_b16 v[216:217], v248 offset:44032
ds_read_b64_tr_b16 v[94:95], v193 offset:25088
s_waitcnt lgkmcnt(11)
v_mfma_f32_32x32x16_bf16 v[128:143], v[56:59], v[220:223], v[128:143]
ds_read_b64_tr_b16 v[218:219], v248 offset:44544
ds_read_b64_tr_b16 v[96:97], v193 offset:28672
v_mfma_f32_32x32x16_bf16 v[144:159], v[60:63], v[220:223], v[144:159]
ds_read_b64_tr_b16 v[220:221], v248 offset:45056
ds_read_b64_tr_b16 v[98:99], v193 offset:29184
s_waitcnt lgkmcnt(11)
v_mfma_f32_32x32x16_bf16 v[128:143], v[64:67], v[208:211], v[128:143]
ds_read_b64_tr_b16 v[222:223], v248 offset:45568
ds_read_b64_tr_b16 v[100:101], v193 offset:32768
v_mfma_f32_32x32x16_bf16 v[144:159], v[68:71], v[208:211], v[144:159]
ds_read_b64_tr_b16 v[208:209], v248 offset:46080
ds_read_b64_tr_b16 v[102:103], v193 offset:33280
s_waitcnt lgkmcnt(11)
v_mfma_f32_32x32x16_bf16 v[128:143], v[72:75], v[212:215], v[128:143]
ds_read_b64_tr_b16 v[210:211], v248 offset:46592
ds_read_b64_tr_b16 v[104:105], v193 offset:36864
v_mfma_f32_32x32x16_bf16 v[144:159], v[76:79], v[212:215], v[144:159]
ds_read_b64_tr_b16 v[212:213], v248 offset:47104
ds_read_b64_tr_b16 v[106:107], v193 offset:37376
s_waitcnt lgkmcnt(11)
v_mfma_f32_32x32x16_bf16 v[128:143], v[80:83], v[216:219], v[128:143]
ds_read_b64_tr_b16 v[214:215], v248 offset:47616
ds_read_b64_tr_b16 v[108:109], v193 offset:40960
v_mfma_f32_32x32x16_bf16 v[144:159], v[84:87], v[216:219], v[144:159]
ds_read_b64_tr_b16 v[216:217], v248 offset:48128
ds_read_b64_tr_b16 v[110:111], v193 offset:41472
s_waitcnt lgkmcnt(11)
v_mfma_f32_32x32x16_bf16 v[128:143], v[88:91], v[220:223], v[128:143]
ds_read_b64_tr_b16 v[218:219], v248 offset:48640
ds_read_b64_tr_b16 v[112:113], v193 offset:45056
v_mfma_f32_32x32x16_bf16 v[144:159], v[92:95], v[220:223], v[144:159]
ds_read_b64_tr_b16 v[220:221], v248 offset:49152
ds_read_b64_tr_b16 v[114:115], v193 offset:45568
s_waitcnt lgkmcnt(11)
v_mfma_f32_32x32x16_bf16 v[128:143], v[96:99], v[208:211], v[128:143]
ds_read_b64_tr_b16 v[222:223], v248 offset:49664
ds_read_b64_tr_b16 v[116:117], v193 offset:49152
v_mfma_f32_32x32x16_bf16 v[144:159], v[100:103], v[208:211], v[144:159]
v_add_u32 v248, 33792, v248
ds_read_b64_tr_b16 v[208:209], v248 offset:16384
ds_read_b64_tr_b16 v[118:119], v193 offset:49664
s_waitcnt lgkmcnt(8)
v_mfma_f32_32x32x16_bf16 v[128:143], v[104:107], v[212:215], v[128:143]
ds_read_b64_tr_b16 v[210:211], v248 offset:16896
ds_read_b64_tr_b16 v[120:121], v193 offset:53248
v_mfma_f32_32x32x16_bf16 v[144:159], v[108:111], v[212:215], v[144:159]
ds_read_b64_tr_b16 v[212:213], v248 offset:17408
ds_read_b64_tr_b16 v[122:123], v193 offset:53760
s_waitcnt lgkmcnt(4)
v_mfma_f32_32x32x16_bf16 v[128:143], v[112:115], v[216:219], v[128:143]
ds_read_b64_tr_b16 v[214:215], v248 offset:17920
ds_read_b64_tr_b16 v[124:125], v193 offset:57344
v_mfma_f32_32x32x16_bf16 v[144:159], v[116:119], v[216:219], v[144:159]
ds_read_b64_tr_b16 v[216:217], v248 offset:18432
ds_read_b64_tr_b16 v[126:127], v193 offset:57856
s_waitcnt lgkmcnt(0)
v_mfma_f32_32x32x16_bf16 v[128:143], v[120:123], v[220:223], v[128:143]
ds_read_b64_tr_b16 v[218:219], v248 offset:18944
v_mfma_f32_32x32x16_bf16 v[144:159], v[124:127], v[220:223], v[144:159]
ds_read_b64_tr_b16 v[220:221], v248 offset:19456
v_mfma_f32_32x32x16_bf16 v[160:175], v[0:3], v[208:211], 0
ds_read_b64_tr_b16 v[222:223], v248 offset:19968
v_mfma_f32_32x32x16_bf16 v[176:191], v[4:7], v[208:211], 0
ds_read_b64_tr_b16 v[208:209], v248 offset:20480
v_mfma_f32_32x32x16_bf16 v[160:175], v[8:11], v[212:215], v[160:175]
ds_read_b64_tr_b16 v[210:211], v248 offset:20992
v_mfma_f32_32x32x16_bf16 v[176:191], v[12:15], v[212:215], v[176:191]
ds_read_b64_tr_b16 v[212:213], v248 offset:21504
s_waitcnt lgkmcnt(5)
v_mfma_f32_32x32x16_bf16 v[160:175], v[16:19], v[216:219], v[160:175]
ds_read_b64_tr_b16 v[214:215], v248 offset:22016
v_cvt_pk_bf16_f32 v128, v128, v129
v_cvt_pk_bf16_f32 v129, v130, v131
v_cvt_pk_bf16_f32 v130, v132, v133
v_cvt_pk_bf16_f32 v131, v134, v135
v_mfma_f32_32x32x16_bf16 v[176:191], v[20:23], v[216:219], v[176:191]
ds_read_b32 v200, v198
ds_write_b128 v194, v[128:131] offset:0
v_cvt_pk_bf16_f32 v136, v136, v137
s_waitcnt lgkmcnt(6)
v_mfma_f32_32x32x16_bf16 v[160:175], v[24:27], v[220:223], v[160:175]
ds_read_b64_tr_b16 v[216:217], v248 offset:22528
v_cvt_pk_bf16_f32 v137, v138, v139
v_cvt_pk_bf16_f32 v138, v140, v141
v_cvt_pk_bf16_f32 v139, v142, v143
v_mfma_f32_32x32x16_bf16 v[176:191], v[28:31], v[220:223], v[176:191]
ds_read_b64_tr_b16 v[218:219], v248 offset:23040
ds_write_b128 v194, v[136:139] offset:32
s_waitcnt lgkmcnt(7)
v_mfma_f32_32x32x16_bf16 v[160:175], v[32:35], v[208:211], v[160:175]
ds_read_b64_tr_b16 v[220:221], v248 offset:23552
v_cvt_pk_bf16_f32 v144, v144, v145
v_cvt_pk_bf16_f32 v145, v146, v147
v_cvt_pk_bf16_f32 v146, v148, v149
v_cvt_pk_bf16_f32 v147, v150, v151
v_mfma_f32_32x32x16_bf16 v[176:191], v[36:39], v[208:211], v[176:191]
ds_read_b64_tr_b16 v[222:223], v248 offset:24064
ds_write_b128 v194, v[144:147] offset:64
s_waitcnt lgkmcnt(8)
v_mfma_f32_32x32x16_bf16 v[160:175], v[40:43], v[212:215], v[160:175]
s_waitcnt lgkmcnt(7)
v_cmp_gt_u32 vcc, 35, v200
s_cbranch_vccnz L_waitPs35
L_goPs35:
v_cvt_pk_bf16_f32 v152, v152, v153
v_cvt_pk_bf16_f32 v153, v154, v155
v_cvt_pk_bf16_f32 v154, v156, v157
v_cvt_pk_bf16_f32 v155, v158, v159
v_mfma_f32_32x32x16_bf16 v[176:191], v[44:47], v[212:215], v[176:191]
ds_read_b64_tr_b16 v[208:209], v248 offset:24576
ds_write_b128 v194, v[152:155] offset:96
s_waitcnt lgkmcnt(6)
v_mfma_f32_32x32x16_bf16 v[160:175], v[48:51], v[216:219], v[160:175]
ds_read_b64_tr_b16 v[210:211], v248 offset:25088
ds_read_b128 v[132:135], v195 offset:0
v_mfma_f32_32x32x16_bf16 v[176:191], v[52:55], v[216:219], v[176:191]
ds_read_b64_tr_b16 v[212:213], v248 offset:25600
ds_read_b128 v[140:143], v195 offset:1152
s_waitcnt lgkmcnt(7)
v_mfma_f32_32x32x16_bf16 v[160:175], v[56:59], v[220:223], v[160:175]
ds_read_b64_tr_b16 v[214:215], v248 offset:26112
ds_read_b128 v[148:151], v195 offset:2304
v_mfma_f32_32x32x16_bf16 v[176:191], v[60:63], v[220:223], v[176:191]
ds_read_b64_tr_b16 v[216:217], v248 offset:26624
ds_read_b128 v[156:159], v195 offset:3456
s_waitcnt lgkmcnt(7)
v_mfma_f32_32x32x16_bf16 v[160:175], v[64:67], v[208:211], v[160:175]
ds_read_b64_tr_b16 v[218:219], v248 offset:27136
s_mov_b32 s31, 28672
s_waitcnt lgkmcnt(7)
s_mov_b32 exec_lo, 0xffffff00
buffer_store_dwordx4 v[132:135], v197, s[20:23], s31 offen sc1 nt
s_mov_b64 exec, -1
v_mfma_f32_32x32x16_bf16 v[176:191], v[68:71], v[208:211], v[176:191]
ds_read_b64_tr_b16 v[220:221], v248 offset:27648
ds_read_b64_tr_b16 v[222:223], v248 offset:28160
s_waitcnt lgkmcnt(6)
v_mfma_f32_32x32x16_bf16 v[160:175], v[72:75], v[212:215], v[160:175]
ds_read_b64_tr_b16 v[208:209], v248 offset:28672
s_mov_b32 s31, 24576
buffer_store_dwordx4 v[140:143], v197, s[20:23], s31 offen sc1 nt
v_mfma_f32_32x32x16_bf16 v[176:191], v[76:79], v[212:215], v[176:191]
ds_read_b64_tr_b16 v[210:211], v248 offset:29184
ds_read_b64_tr_b16 v[212:213], v248 offset:29696
s_waitcnt lgkmcnt(5)
v_mfma_f32_32x32x16_bf16 v[160:175], v[80:83], v[216:219], v[160:175]
ds_read_b64_tr_b16 v[214:215], v248 offset:30208
v_mfma_f32_32x32x16_bf16 v[176:191], v[84:87], v[216:219], v[176:191]
ds_read_b64_tr_b16 v[216:217], v248 offset:30720
s_waitcnt lgkmcnt(5)
v_mfma_f32_32x32x16_bf16 v[160:175], v[88:91], v[220:223], v[160:175]
ds_read_b64_tr_b16 v[218:219], v248 offset:31232
v_mfma_f32_32x32x16_bf16 v[176:191], v[92:95], v[220:223], v[176:191]
ds_read_b64_tr_b16 v[220:221], v248 offset:31744
s_waitcnt lgkmcnt(5)
v_mfma_f32_32x32x16_bf16 v[160:175], v[96:99], v[208:211], v[160:175]
ds_read_b64_tr_b16 v[222:223], v248 offset:32256
s_mov_b32 s31, 0
s_mov_b32 exec_lo, 0xffffff00
buffer_store_dwordx4 v[148:151], v196, s[20:23], s31 offen sc1 nt
s_mov_b64 exec, -1
v_mfma_f32_32x32x16_bf16 v[176:191], v[100:103], v[208:211], v[176:191]
v_add_u32 v248, -33792, v248
ds_read_b64_tr_b16 v[208:209], v248 offset:0
s_waitcnt lgkmcnt(5)
v_mfma_f32_32x32x16_bf16 v[160:175], v[104:107], v[212:215], v[160:175]
ds_read_b64_tr_b16 v[210:211], v248 offset:512
v_mfma_f32_32x32x16_bf16 v[176:191], v[108:111], v[212:215], v[176:191]
ds_read_b64_tr_b16 v[212:213], v248 offset:1024
s_waitcnt lgkmcnt(5)
v_mfma_f32_32x32x16_bf16 v[160:175], v[112:115], v[216:219], v[160:175]
ds_read_b64_tr_b16 v[214:215], v248 offset:1536
v_mfma_f32_32x32x16_bf16 v[176:191], v[116:119], v[216:219], v[176:191]
ds_read_b64_tr_b16 v[216:217], v248 offset:2048
s_waitcnt lgkmcnt(5)
v_mfma_f32_32x32x16_bf16 v[160:175], v[120:123], v[220:223], v[160:175]
ds_read_b64_tr_b16 v[218:219], v248 offset:2560
s_mov_b32 s31, 4096
buffer_store_dwordx4 v[156:159], v196, s[20:23], s31 offen sc1 nt
v_mfma_f32_32x32x16_bf16 v[176:191], v[124:127], v[220:223], v[176:191]
ds_read_b64_tr_b16 v[220:221], v248 offset:3072
s_waitcnt lgkmcnt(5)
v_mfma_f32_32x32x16_bf16 v[128:143], v[0:3], v[208:211], 0
ds_read_b64_tr_b16 v[222:223], v248 offset:3584
v_mfma_f32_32x32x16_bf16 v[144:159], v[4:7], v[208:211], 0
ds_read_b64_tr_b16 v[208:209], v248 offset:4096
s_waitcnt lgkmcnt(5)
v_mfma_f32_32x32x16_bf16 v[128:143], v[8:11], v[212:215], v[128:143]
ds_read_b64_tr_b16 v[210:211], v248 offset:4608
v_mfma_f32_32x32x16_bf16 v[144:159], v[12:15], v[212:215], v[144:159]
ds_read_b64_tr_b16 v[212:213], v248 offset:5120
s_waitcnt lgkmcnt(5)
v_mfma_f32_32x32x16_bf16 v[128:143], v[16:19], v[216:219], v[128:143]
ds_read_b64_tr_b16 v[214:215], v248 offset:5632
v_cvt_pk_bf16_f32 v160, v160, v161
v_cvt_pk_bf16_f32 v161, v162, v163
v_cvt_pk_bf16_f32 v162, v164, v165
v_cvt_pk_bf16_f32 v163, v166, v167
v_mfma_f32_32x32x16_bf16 v[144:159], v[20:23], v[216:219], v[144:159]
ds_read_b32 v200, v198
ds_write_b128 v194, v[160:163] offset:0
v_cvt_pk_bf16_f32 v168, v168, v169
s_waitcnt lgkmcnt(6)
v_mfma_f32_32x32x16_bf16 v[128:143], v[24:27], v[220:223], v[128:143]
ds_read_b64_tr_b16 v[216:217], v248 offset:6144
v_cvt_pk_bf16_f32 v169, v170, v171
v_cvt_pk_bf16_f32 v170, v172, v173
v_cvt_pk_bf16_f32 v171, v174, v175
v_mfma_f32_32x32x16_bf16 v[144:159], v[28:31], v[220:223], v[144:159]
ds_read_b64_tr_b16 v[218:219], v248 offset:6656
ds_write_b128 v194, v[168:171] offset:32
s_waitcnt lgkmcnt(7)
v_mfma_f32_32x32x16_bf16 v[128:143], v[32:35], v[208:211], v[128:143]
ds_read_b64_tr_b16 v[220:221], v248 offset:7168
v_cvt_pk_bf16_f32 v176, v176, v177
v_cvt_pk_bf16_f32 v177, v178, v179
v_cvt_pk_bf16_f32 v178, v180, v181
v_cvt_pk_bf16_f32 v179, v182, v183
v_mfma_f32_32x32x16_bf16 v[144:159], v[36:39], v[208:211], v[144:159]
ds_read_b64_tr_b16 v[222:223], v248 offset:7680
ds_write_b128 v194, v[176:179] offset:64
s_waitcnt lgkmcnt(8)
v_mfma_f32_32x32x16_bf16 v[128:143], v[40:43], v[212:215], v[128:143]
s_waitcnt lgkmcnt(7)
v_cmp_gt_u32 vcc, 40, v200
s_cbranch_vccnz L_waitPs40
L_goPs40:
v_cvt_pk_bf16_f32 v184, v184, v185
v_cvt_pk_bf16_f32 v185, v186, v187
v_cvt_pk_bf16_f32 v186, v188, v189
v_cvt_pk_bf16_f32 v187, v190, v191
v_mfma_f32_32x32x16_bf16 v[144:159], v[44:47], v[212:215], v[144:159]
ds_read_b64_tr_b16 v[208:209], v248 offset:8192
ds_write_b128 v194, v[184:187] offset:96
s_waitcnt lgkmcnt(6)
v_mfma_f32_32x32x16_bf16 v[128:143], v[48:51], v[216:219], v[128:143]
ds_read_b64_tr_b16 v[210:211], v248 offset:8704
ds_read_b128 v[164:167], v195 offset:0
v_mfma_f32_32x32x16_bf16 v[144:159], v[52:55], v[216:219], v[144:159]
ds_read_b64_tr_b16 v[212:213], v248 offset:9216
ds_read_b128 v[172:175], v195 offset:1152
s_waitcnt lgkmcnt(7)
v_mfma_f32_32x32x16_bf16 v[128:143], v[56:59], v[220:223], v[128:143]
ds_read_b64_tr_b16 v[214:215], v248 offset:9728
ds_read_b128 v[180:183], v195 offset:2304
v_mfma_f32_32x32x16_bf16 v[144:159], v[60:63], v[220:223], v[144:159]
ds_read_b64_tr_b16 v[216:217], v248 offset:10240
ds_read_b128 v[188:191], v195 offset:3456
s_waitcnt lgkmcnt(7)
v_mfma_f32_32x32x16_bf16 v[128:143], v[64:67], v[208:211], v[128:143]
ds_read_b64_tr_b16 v[218:219], v248 offset:10752
s_mov_b32 s31, 20480
s_waitcnt lgkmcnt(7)
buffer_store_dwordx4 v[164:167], v197, s[20:23], s31 offen sc1 nt
v_mfma_f32_32x32x16_bf16 v[144:159], v[68:71], v[208:211], v[144:159]
ds_read_b64_tr_b16 v[220:221], v248 offset:11264
ds_read_b64_tr_b16 v[222:223], v248 offset:11776
s_waitcnt lgkmcnt(6)
v_mfma_f32_32x32x16_bf16 v[128:143], v[72:75], v[212:215], v[128:143]
ds_read_b64_tr_b16 v[208:209], v248 offset:12288
s_mov_b32 s31, 16384
buffer_store_dwordx4 v[172:175], v197, s[20:23], s31 offen sc1 nt
v_mfma_f32_32x32x16_bf16 v[144:159], v[76:79], v[212:215], v[144:159]
ds_read_b64_tr_b16 v[210:211], v248 offset:12800
ds_read_b64_tr_b16 v[212:213], v248 offset:13312
s_waitcnt lgkmcnt(5)
v_mfma_f32_32x32x16_bf16 v[128:143], v[80:83], v[216:219], v[128:143]
ds_read_b64_tr_b16 v[214:215], v248 offset:13824
v_mfma_f32_32x32x16_bf16 v[144:159], v[84:87], v[216:219], v[144:159]
ds_read_b64_tr_b16 v[216:217], v248 offset:14336
s_waitcnt lgkmcnt(5)
v_mfma_f32_32x32x16_bf16 v[128:143], v[88:91], v[220:223], v[128:143]
ds_read_b64_tr_b16 v[218:219], v248 offset:14848
v_mfma_f32_32x32x16_bf16 v[144:159], v[92:95], v[220:223], v[144:159]
ds_read_b64_tr_b16 v[220:221], v248 offset:15360
s_waitcnt lgkmcnt(5)
v_mfma_f32_32x32x16_bf16 v[128:143], v[96:99], v[208:211], v[128:143]
ds_read_b64_tr_b16 v[222:223], v248 offset:15872
s_mov_b32 s31, 8192
buffer_store_dwordx4 v[180:183], v196, s[20:23], s31 offen sc1 nt
v_mfma_f32_32x32x16_bf16 v[144:159], v[100:103], v[208:211], v[144:159]
ds_read_b64_tr_b16 v[208:209], v248 offset:16896
s_waitcnt lgkmcnt(5)
v_mfma_f32_32x32x16_bf16 v[128:143], v[104:107], v[212:215], v[128:143]
ds_read_b64_tr_b16 v[210:211], v248 offset:17408
v_mfma_f32_32x32x16_bf16 v[144:159], v[108:111], v[212:215], v[144:159]
ds_read_b64_tr_b16 v[212:213], v248 offset:17920
s_waitcnt lgkmcnt(5)
v_mfma_f32_32x32x16_bf16 v[128:143], v[112:115], v[216:219], v[128:143]
ds_read_b64_tr_b16 v[214:215], v248 offset:18432
v_mfma_f32_32x32x16_bf16 v[144:159], v[116:119], v[216:219], v[144:159]
ds_read_b64_tr_b16 v[216:217], v248 offset:18944
s_waitcnt lgkmcnt(5)
v_mfma_f32_32x32x16_bf16 v[128:143], v[120:123], v[220:223], v[128:143]
ds_read_b64_tr_b16 v[218:219], v248 offset:19456
s_mov_b32 s31, 12288
buffer_store_dwordx4 v[188:191], v196, s[20:23], s31 offen sc1 nt
v_mfma_f32_32x32x16_bf16 v[144:159], v[124:127], v[220:223], v[144:159]
ds_read_b64_tr_b16 v[220:221], v248 offset:19968
s_waitcnt lgkmcnt(5)
v_mfma_f32_32x32x16_bf16 v[160:175], v[0:3], v[208:211], 0
ds_read_b64_tr_b16 v[222:223], v248 offset:20480
v_mfma_f32_32x32x16_bf16 v[176:191], v[4:7], v[208:211], 0
ds_read_b64_tr_b16 v[208:209], v248 offset:20992
s_waitcnt lgkmcnt(5)
v_mfma_f32_32x32x16_bf16 v[160:175], v[8:11], v[212:215], v[160:175]
ds_read_b64_tr_b16 v[210:211], v248 offset:21504
v_mfma_f32_32x32x16_bf16 v[176:191], v[12:15], v[212:215], v[176:191]
ds_read_b64_tr_b16 v[212:213], v248 offset:22016
s_waitcnt lgkmcnt(5)
v_mfma_f32_32x32x16_bf16 v[160:175], v[16:19], v[216:219], v[160:175]
ds_read_b64_tr_b16 v[214:215], v248 offset:22528
v_cvt_pk_bf16_f32 v128, v128, v129
v_cvt_pk_bf16_f32 v129, v130, v131
v_cvt_pk_bf16_f32 v130, v132, v133
v_cvt_pk_bf16_f32 v131, v134, v135
v_mfma_f32_32x32x16_bf16 v[176:191], v[20:23], v[216:219], v[176:191]
ds_read_b32 v200, v198
ds_write_b128 v194, v[128:131] offset:0
v_cvt_pk_bf16_f32 v136, v136, v137
s_waitcnt lgkmcnt(6)
v_mfma_f32_32x32x16_bf16 v[160:175], v[24:27], v[220:223], v[160:175]
ds_read_b64_tr_b16 v[216:217], v248 offset:23040
v_cvt_pk_bf16_f32 v137, v138, v139
v_cvt_pk_bf16_f32 v138, v140, v141
v_cvt_pk_bf16_f32 v139, v142, v143
v_mfma_f32_32x32x16_bf16 v[176:191], v[28:31], v[220:223], v[176:191]
ds_read_b64_tr_b16 v[218:219], v248 offset:23552
ds_write_b128 v194, v[136:139] offset:32
s_waitcnt lgkmcnt(7)
v_mfma_f32_32x32x16_bf16 v[160:175], v[32:35], v[208:211], v[160:175]
ds_read_b64_tr_b16 v[220:221], v248 offset:24064
v_cvt_pk_bf16_f32 v144, v144, v145
v_cvt_pk_bf16_f32 v145, v146, v147
v_cvt_pk_bf16_f32 v146, v148, v149
v_cvt_pk_bf16_f32 v147, v150, v151
v_mfma_f32_32x32x16_bf16 v[176:191], v[36:39], v[208:211], v[176:191]
ds_read_b64_tr_b16 v[222:223], v248 offset:24576
ds_write_b128 v194, v[144:147] offset:64
s_waitcnt lgkmcnt(8)
v_mfma_f32_32x32x16_bf16 v[160:175], v[40:43], v[212:215], v[160:175]
s_waitcnt lgkmcnt(7)
v_cmp_gt_u32 vcc, 50, v200
s_cbranch_vccnz L_waitPs50
L_goPs50:
v_cvt_pk_bf16_f32 v152, v152, v153
v_cvt_pk_bf16_f32 v153, v154, v155
v_cvt_pk_bf16_f32 v154, v156, v157
v_cvt_pk_bf16_f32 v155, v158, v159
v_mfma_f32_32x32x16_bf16 v[176:191], v[44:47], v[212:215], v[176:191]
ds_read_b64_tr_b16 v[208:209], v248 offset:25088
ds_write_b128 v194, v[152:155] offset:96
s_waitcnt lgkmcnt(6)
v_mfma_f32_32x32x16_bf16 v[160:175], v[48:51], v[216:219], v[160:175]
ds_read_b64_tr_b16 v[210:211], v248 offset:25600
ds_read_b128 v[132:135], v195 offset:0
v_mfma_f32_32x32x16_bf16 v[176:191], v[52:55], v[216:219], v[176:191]
ds_read_b64_tr_b16 v[212:213], v248 offset:26112
ds_read_b128 v[140:143], v195 offset:1152
s_waitcnt lgkmcnt(7)
v_mfma_f32_32x32x16_bf16 v[160:175], v[56:59], v[220:223], v[160:175]
ds_read_b64_tr_b16 v[214:215], v248 offset:26624
ds_read_b128 v[148:151], v195 offset:2304
v_mfma_f32_32x32x16_bf16 v[176:191], v[60:63], v[220:223], v[176:191]
ds_read_b64_tr_b16 v[216:217], v248 offset:27136
ds_read_b128 v[156:159], v195 offset:3456
s_waitcnt lgkmcnt(7)
v_mfma_f32_32x32x16_bf16 v[160:175], v[64:67], v[208:211], v[160:175]
ds_read_b64_tr_b16 v[218:219], v248 offset:27648
s_mov_b32 s31, 12288
s_waitcnt lgkmcnt(7)
buffer_store_dwordx4 v[132:135], v197, s[20:23], s31 offen sc1 nt
v_mfma_f32_32x32x16_bf16 v[176:191], v[68:71], v[208:211], v[176:191]
ds_read_b64_tr_b16 v[220:221], v248 offset:28160
ds_read_b64_tr_b16 v[222:223], v248 offset:28672
s_waitcnt lgkmcnt(6)
v_mfma_f32_32x32x16_bf16 v[160:175], v[72:75], v[212:215], v[160:175]
ds_read_b64_tr_b16 v[208:209], v248 offset:29184
s_mov_b32 s31, 8192
buffer_store_dwordx4 v[140:143], v197, s[20:23], s31 offen sc1 nt
v_mfma_f32_32x32x16_bf16 v[176:191], v[76:79], v[212:215], v[176:191]
ds_read_b64_tr_b16 v[210:211], v248 offset:29696
ds_read_b64_tr_b16 v[212:213], v248 offset:30208
s_waitcnt lgkmcnt(5)
v_mfma_f32_32x32x16_bf16 v[160:175], v[80:83], v[216:219], v[160:175]
ds_read_b64_tr_b16 v[214:215], v248 offset:30720
v_mfma_f32_32x32x16_bf16 v[176:191], v[84:87], v[216:219], v[176:191]
ds_read_b64_tr_b16 v[216:217], v248 offset:31232
s_waitcnt lgkmcnt(5)
v_mfma_f32_32x32x16_bf16 v[160:175], v[88:91], v[220:223], v[160:175]
ds_read_b64_tr_b16 v[218:219], v248 offset:31744
v_mfma_f32_32x32x16_bf16 v[176:191], v[92:95], v[220:223], v[176:191]
ds_read_b64_tr_b16 v[220:221], v248 offset:32256
s_waitcnt lgkmcnt(5)
v_mfma_f32_32x32x16_bf16 v[160:175], v[96:99], v[208:211], v[160:175]
ds_read_b64_tr_b16 v[222:223], v248 offset:32768
s_mov_b32 s31, 16384
buffer_store_dwordx4 v[148:151], v196, s[20:23], s31 offen sc1 nt
v_mfma_f32_32x32x16_bf16 v[176:191], v[100:103], v[208:211], v[176:191]
s_waitcnt lgkmcnt(4)
v_mfma_f32_32x32x16_bf16 v[160:175], v[104:107], v[212:215], v[160:175]
v_mfma_f32_32x32x16_bf16 v[176:191], v[108:111], v[212:215], v[176:191]
s_waitcnt lgkmcnt(2)
v_mfma_f32_32x32x16_bf16 v[160:175], v[112:115], v[216:219], v[160:175]
v_mfma_f32_32x32x16_bf16 v[176:191], v[116:119], v[216:219], v[176:191]
s_waitcnt lgkmcnt(0)
v_mfma_f32_32x32x16_bf16 v[160:175], v[120:123], v[220:223], v[160:175]
s_mov_b32 s31, 20480
buffer_store_dwordx4 v[156:159], v196, s[20:23], s31 offen sc1 nt
v_mfma_f32_32x32x16_bf16 v[176:191], v[124:127], v[220:223], v[176:191]
s_nop 10
v_cvt_pk_bf16_f32 v160, v160, v161
v_cvt_pk_bf16_f32 v161, v162, v163
v_cvt_pk_bf16_f32 v162, v164, v165
v_cvt_pk_bf16_f32 v163, v166, v167
ds_write_b128 v194, v[160:163] offset:0
v_cvt_pk_bf16_f32 v168, v168, v169
v_cvt_pk_bf16_f32 v169, v170, v171
v_cvt_pk_bf16_f32 v170, v172, v173
v_cvt_pk_bf16_f32 v171, v174, v175
ds_write_b128 v194, v[168:171] offset:32
v_cvt_pk_bf16_f32 v176, v176, v177
v_cvt_pk_bf16_f32 v177, v178, v179
v_cvt_pk_bf16_f32 v178, v180, v181
v_cvt_pk_bf16_f32 v179, v182, v183
ds_write_b128 v194, v[176:179] offset:64
v_cvt_pk_bf16_f32 v184, v184, v185
v_cvt_pk_bf16_f32 v185, v186, v187
v_cvt_pk_bf16_f32 v186, v188, v189
v_cvt_pk_bf16_f32 v187, v190, v191
ds_write_b128 v194, v[184:187] offset:96
ds_read_b128 v[164:167], v195 offset:0
ds_read_b128 v[172:175], v195 offset:1152
ds_read_b128 v[180:183], v195 offset:2304
ds_read_b128 v[188:191], v195 offset:3456
s_mov_b32 s31, 4096
s_waitcnt lgkmcnt(3)
buffer_store_dwordx4 v[164:167], v197, s[20:23], s31 offen sc1 nt
s_mov_b32 s31, 0
s_waitcnt lgkmcnt(2)
buffer_store_dwordx4 v[172:175], v197, s[20:23], s31 offen sc1 nt
s_mov_b32 s31, 24576
s_waitcnt lgkmcnt(1)
buffer_store_dwordx4 v[180:183], v196, s[20:23], s31 offen sc1 nt
s_mov_b32 s31, 28672
s_waitcnt lgkmcnt(0)
s_mov_b32 exec_hi, 0x00ffffff
buffer_store_dwordx4 v[188:191], v196, s[20:23], s31 offen sc1 nt
s_mov_b64 exec, -1
s_endpgm
L_waitPs5:
ds_read_b32 v200, v198
s_waitcnt lgkmcnt(0)
v_cmp_gt_u32 vcc, 5, v200
s_cbranch_vccnz L_waitPs5
s_branch L_goPs5
L_waitPs10:
ds_read_b32 v200, v198
s_waitcnt lgkmcnt(0)
v_cmp_gt_u32 vcc, 10, v200
s_cbranch_vccnz L_waitPs10
s_branch L_goPs10
L_waitPs20:
ds_read_b32 v200, v198
s_waitcnt lgkmcnt(0)
v_cmp_gt_u32 vcc, 20, v200
s_cbranch_vccnz L_waitPs20
s_branch L_goPs20
L_waitPs30:
ds_read_b32 v200, v198
s_waitcnt lgkmcnt(0)
v_cmp_gt_u32 vcc, 30, v200
s_cbranch_vccnz L_waitPs30
s_branch L_goPs30
L_waitPs35:
ds_read_b32 v200, v198
s_waitcnt lgkmcnt(0)
v_cmp_gt_u32 vcc, 35, v200
s_cbranch_vccnz L_waitPs35
s_branch L_goPs35
L_waitPs40:
ds_read_b32 v200, v198
s_waitcnt lgkmcnt(0)
v_cmp_gt_u32 vcc, 40, v200
s_cbranch_vccnz L_waitPs40
s_branch L_goPs40
L_waitPs50:
ds_read_b32 v200, v198
s_waitcnt lgkmcnt(0)
v_cmp_gt_u32 vcc, 50, v200
s_cbranch_vccnz L_waitPs50
s_branch L_goPs50
L_slowQ:
s_nop 5
s_waitcnt vmcnt(4)
v_mov_b32 v254, 10
ds_write_b32 v249, v254
v_mul_f32 v144, s28, v144
v_mul_f32 v145, s28, v145
v_mul_f32 v146, s28, v146
v_mul_f32 v147, s28, v147
v_mul_f32 v148, s28, v148
v_mul_f32 v149, s28, v149
v_mul_f32 v150, s28, v150
v_mul_f32 v151, s28, v151
v_mul_f32 v152, s28, v152
v_mul_f32 v153, s28, v153
v_mul_f32 v154, s28, v154
v_mul_f32 v155, s28, v155
v_mul_f32 v156, s28, v156
v_mul_f32 v157, s28, v157
v_mul_f32 v158, s28, v158
v_mul_f32 v159, s28, v159
v_exp_f32 v144, v144
v_exp_f32 v145, v145
v_exp_f32 v146, v146
v_exp_f32 v147, v147
v_exp_f32 v148, v148
v_exp_f32 v149, v149
v_exp_f32 v150, v150
v_exp_f32 v151, v151
v_exp_f32 v152, v152
v_exp_f32 v153, v153
v_exp_f32 v154, v154
v_exp_f32 v155, v155
v_exp_f32 v156, v156
v_exp_f32 v157, v157
v_exp_f32 v158, v158
v_exp_f32 v159, v159
v_add_f32 v144, 1.0, v144
v_add_f32 v145, 1.0, v145
v_add_f32 v146, 1.0, v146
v_add_f32 v147, 1.0, v147
v_add_f32 v148, 1.0, v148
v_add_f32 v149, 1.0, v149
v_add_f32 v150, 1.0, v150
v_add_f32 v151, 1.0, v151
v_add_f32 v152, 1.0, v152
v_add_f32 v153, 1.0, v153
v_add_f32 v154, 1.0, v154
v_add_f32 v155, 1.0, v155
v_add_f32 v156, 1.0, v156
v_add_f32 v157, 1.0, v157
v_add_f32 v158, 1.0, v158
v_add_f32 v159, 1.0, v159
v_rcp_f32 v144, v144
v_rcp_f32 v145, v145
v_rcp_f32 v146, v146
v_rcp_f32 v147, v147
v_rcp_f32 v148, v148
v_rcp_f32 v149, v149
v_rcp_f32 v150, v150
v_rcp_f32 v151, v151
v_rcp_f32 v152, v152
v_rcp_f32 v153, v153
v_rcp_f32 v154, v154
v_rcp_f32 v155, v155
v_rcp_f32 v156, v156
v_rcp_f32 v157, v157
v_rcp_f32 v158, v158
v_rcp_f32 v159, v159
v_mul_f32 v128, v128, v144
v_mul_f32 v129, v129, v145
v_mov_b32 v243, v128
v_mov_b32 v244, v128
v_cmp_gt_u32 vcc, 32, v255
v_mul_f32 v130, v130, v146
v_mul_f32 v131, v131, v147
v_mul_f32 v132, v132, v148
v_permlane32_swap_b32 v243, v244
v_mul_f32 v133, v133, v149
v_mul_f32 v134, v134, v150
v_mul_f32 v135, v135, v151
v_cndmask_b32 v244, v243, v244, vcc
v_mul_f32 v136, v136, v152
v_mul_f32 v137, v137, v153
v_mul_f32 v138, v138, v154
v_mul_f32 v139, v139, v155
v_mul_f32 v140, v140, v156
v_mul_f32 v141, v141, v157
v_mul_f32 v251, v142, v158
v_mul_f32 v252, v143, v159
v_mul_f32 v144, v240, v244
v_mul_f32 v145, v240, v128
v_mul_f32 v146, v240, v129
v_mul_f32 v147, v240, v130
v_mul_f32 v148, v240, v131
v_mul_f32 v149, v240, v132
v_mul_f32 v150, v240, v133
v_mul_f32 v151, v240, v134
v_mul_f32 v152, v240, v135
v_mul_f32 v153, v240, v136
v_mul_f32 v154, v240, v137
v_mul_f32 v155, v240, v138
v_mul_f32 v156, v240, v139
v_mul_f32 v157, v240, v140
v_mul_f32 v158, v240, v141
s_waitcnt vmcnt(0)
v_mov_b32 v254, 25
ds_write_b32 v249, v254
s_setprio 1
v_mul_f32 v159, v240, v251
v_fmac_f32 v144, v242, v128
v_fmac_f32 v145, v242, v129
v_fmac_f32 v146, v242, v130
v_fmac_f32 v147, v242, v131
v_fmac_f32 v148, v242, v132
v_fmac_f32 v149, v242, v133
v_fmac_f32 v150, v242, v134
v_fmac_f32 v151, v242, v135
v_fmac_f32 v152, v242, v136
v_fmac_f32 v153, v242, v137
v_fmac_f32 v154, v242, v138
v_fmac_f32 v155, v242, v139
v_fmac_f32 v156, v242, v140
v_fmac_f32 v157, v242, v141
v_fmac_f32 v158, v242, v251
v_fmac_f32 v159, v242, v252
v_fmac_f32 v144, v241, v243
v_fmac_f32 v145, v241, v244
v_fmac_f32 v146, v241, v128
v_fmac_f32 v147, v241, v129
v_fmac_f32 v148, v241, v130
v_fmac_f32 v149, v241, v131
v_fmac_f32 v150, v241, v132
v_fmac_f32 v151, v241, v133
v_fmac_f32 v152, v241, v134
v_fmac_f32 v153, v241, v135
v_fmac_f32 v154, v241, v136
v_fmac_f32 v155, v241, v137
v_fmac_f32 v156, v241, v138
v_fmac_f32 v157, v241, v139
v_fmac_f32 v158, v241, v140
v_fmac_f32 v159, v241, v141
v_exp_f32 v128, v144
v_exp_f32 v129, v145
v_exp_f32 v130, v146
v_exp_f32 v131, v147
v_exp_f32 v132, v148
v_exp_f32 v133, v149
v_exp_f32 v134, v150
v_exp_f32 v135, v151
v_fma_f32 v128, v128, s28, s28
v_fma_f32 v129, v129, s28, s28
v_fma_f32 v130, v130, s28, s28
v_fma_f32 v131, v131, s28, s28
v_fma_f32 v132, v132, s28, s28
v_fma_f32 v133, v133, s28, s28
v_fma_f32 v134, v134, s28, s28
v_fma_f32 v135, v135, s28, s28
v_rcp_f32 v128, v128
v_rcp_f32 v129, v129
v_rcp_f32 v130, v130
v_rcp_f32 v131, v131
v_rcp_f32 v132, v132
v_rcp_f32 v133, v133
v_rcp_f32 v134, v134
v_rcp_f32 v135, v135
v_mul_f32 v144, v144, v128
v_mul_f32 v145, v145, v129
v_mul_f32 v146, v146, v130
v_mul_f32 v147, v147, v131
v_mul_f32 v148, v148, v132
v_mul_f32 v149, v149, v133
v_mul_f32 v150, v150, v134
v_mul_f32 v151, v151, v135
v_cvt_pk_bf16_f32 v128, v144, v145
v_cvt_pk_bf16_f32 v129, v146, v147
v_cvt_pk_bf16_f32 v130, v148, v149
v_cvt_pk_bf16_f32 v131, v150, v151
ds_write_b128 v246, v[128:131] offset:33792
v_exp_f32 v136, v152
v_exp_f32 v137, v153
v_exp_f32 v138, v154
v_exp_f32 v139, v155
v_exp_f32 v140, v156
v_exp_f32 v141, v157
v_exp_f32 v142, v158
v_exp_f32 v143, v159
v_fma_f32 v136, v136, s28, s28
v_fma_f32 v137, v137, s28, s28
v_fma_f32 v138, v138, s28, s28
v_fma_f32 v139, v139, s28, s28
v_fma_f32 v140, v140, s28, s28
v_fma_f32 v141, v141, s28, s28
v_fma_f32 v142, v142, s28, s28
v_fma_f32 v143, v143, s28, s28
v_rcp_f32 v136, v136
v_rcp_f32 v137, v137
v_rcp_f32 v138, v138
v_rcp_f32 v139, v139
v_rcp_f32 v140, v140
v_rcp_f32 v141, v141
v_rcp_f32 v142, v142
v_rcp_f32 v143, v143
v_mul_f32 v152, v152, v136
v_mul_f32 v153, v153, v137
v_mul_f32 v154, v154, v138
v_mul_f32 v155, v155, v139
v_mul_f32 v156, v156, v140
v_mul_f32 v157, v157, v141
v_mul_f32 v158, v158, v142
v_mul_f32 v159, v159, v143
v_cvt_pk_bf16_f32 v136, v152, v153
v_cvt_pk_bf16_f32 v137, v154, v155
v_cvt_pk_bf16_f32 v138, v156, v157
v_cvt_pk_bf16_f32 v139, v158, v159
ds_write_b128 v247, v[136:139] offset:33792
v_mul_f32 v176, s28, v176
v_mul_f32 v177, s28, v177
v_mul_f32 v178, s28, v178
v_mul_f32 v179, s28, v179
v_mul_f32 v180, s28, v180
v_mul_f32 v181, s28, v181
v_mul_f32 v182, s28, v182
v_mul_f32 v183, s28, v183
v_mul_f32 v184, s28, v184
v_mul_f32 v185, s28, v185
ds_read_b32 v253, v248
v_mul_f32 v186, s28, v186
v_mul_f32 v187, s28, v187
v_mul_f32 v188, s28, v188
v_mul_f32 v189, s28, v189
v_mul_f32 v190, s28, v190
v_mul_f32 v191, s28, v191
v_exp_f32 v176, v176
v_exp_f32 v177, v177
v_exp_f32 v178, v178
v_exp_f32 v179, v179
v_exp_f32 v180, v180
v_exp_f32 v181, v181
v_exp_f32 v182, v182
v_exp_f32 v183, v183
v_exp_f32 v184, v184
s_waitcnt lgkmcnt(0)
v_cmp_gt_u32 vcc, 20, v253
s_cbranch_vccnz L_waitQs20
L_goQs20:
v_exp_f32 v185, v185
v_exp_f32 v186, v186
v_exp_f32 v187, v187
v_exp_f32 v188, v188
v_exp_f32 v189, v189
v_exp_f32 v190, v190
v_exp_f32 v191, v191
v_add_f32 v176, 1.0, v176
v_add_f32 v177, 1.0, v177
v_add_f32 v178, 1.0, v178
v_add_f32 v179, 1.0, v179
v_add_f32 v180, 1.0, v180
v_add_f32 v181, 1.0, v181
v_add_f32 v182, 1.0, v182
v_add_f32 v183, 1.0, v183
v_add_f32 v184, 1.0, v184
v_add_f32 v185, 1.0, v185
v_add_f32 v186, 1.0, v186
v_add_f32 v187, 1.0, v187
v_add_f32 v188, 1.0, v188
v_add_f32 v189, 1.0, v189
v_add_f32 v190, 1.0, v190
v_add_f32 v191, 1.0, v191
v_rcp_f32 v176, v176
v_rcp_f32 v177, v177
v_rcp_f32 v178, v178
v_rcp_f32 v179, v179
v_rcp_f32 v180, v180
v_rcp_f32 v181, v181
v_rcp_f32 v182, v182
v_rcp_f32 v183, v183
v_rcp_f32 v184, v184
v_rcp_f32 v185, v185
v_rcp_f32 v186, v186
v_rcp_f32 v187, v187
v_rcp_f32 v188, v188
v_rcp_f32 v189, v189
v_rcp_f32 v190, v190
v_rcp_f32 v191, v191
v_mul_f32 v160, v160, v176
v_mul_f32 v161, v161, v177
v_mul_f32 v162, v162, v178
v_mul_f32 v163, v163, v179
v_mul_f32 v164, v164, v180
v_mul_f32 v165, v165, v181
v_mul_f32 v166, v166, v182
v_mul_f32 v167, v167, v183
v_mul_f32 v168, v168, v184
v_mul_f32 v169, v169, v185
v_mul_f32 v170, v170, v186
v_mul_f32 v171, v171, v187
v_mul_f32 v172, v172, v188
v_mul_f32 v173, v173, v189
v_mul_f32 v243, v174, v190
v_mul_f32 v244, v175, v191
v_mul_f32 v176, v240, v252
v_mul_f32 v177, v240, v160
v_mul_f32 v178, v240, v161
v_mul_f32 v179, v240, v162
v_mul_f32 v180, v240, v163
v_mul_f32 v181, v240, v164
v_mul_f32 v182, v240, v165
v_mul_f32 v183, v240, v166
v_mul_f32 v184, v240, v167
v_mul_f32 v185, v240, v168
v_mul_f32 v186, v240, v169
v_mul_f32 v187, v240, v170
v_mul_f32 v188, v240, v171
v_mul_f32 v189, v240, v172
v_mul_f32 v190, v240, v173
v_mul_f32 v191, v240, v243
v_fmac_f32 v176, v242, v160
v_fmac_f32 v177, v242, v161
v_fmac_f32 v178, v242, v162
v_fmac_f32 v179, v242, v163
v_fmac_f32 v180, v242, v164
v_fmac_f32 v181, v242, v165
v_fmac_f32 v182, v242, v166
v_fmac_f32 v183, v242, v167
v_fmac_f32 v184, v242, v168
v_fmac_f32 v185, v242, v169
v_fmac_f32 v186, v242, v170
v_fmac_f32 v187, v242, v171
v_fmac_f32 v188, v242, v172
v_fmac_f32 v189, v242, v173
v_fmac_f32 v190, v242, v243
v_fmac_f32 v191, v242, v244
v_fmac_f32 v176, v241, v251
v_fmac_f32 v177, v241, v252
v_fmac_f32 v178, v241, v160
v_fmac_f32 v179, v241, v161
v_fmac_f32 v180, v241, v162
v_fmac_f32 v181, v241, v163
v_fmac_f32 v182, v241, v164
v_fmac_f32 v183, v241, v165
v_fmac_f32 v184, v241, v166
v_fmac_f32 v185, v241, v167
v_fmac_f32 v186, v241, v168
v_fmac_f32 v187, v241, v169
v_fmac_f32 v188, v241, v170
v_fmac_f32 v189, v241, v171
v_fmac_f32 v190, v241, v172
v_fmac_f32 v191, v241, v173
v_exp_f32 v160, v176
v_exp_f32 v161, v177
v_exp_f32 v162, v178
v_exp_f32 v163, v179
v_exp_f32 v164, v180
v_exp_f32 v165, v181
v_exp_f32 v166, v182
v_exp_f32 v167, v183
v_fma_f32 v160, v160, s28, s28
v_fma_f32 v161, v161, s28, s28
v_fma_f32 v162, v162, s28, s28
v_fma_f32 v163, v163, s28, s28
v_fma_f32 v164, v164, s28, s28
v_fma_f32 v165, v165, s28, s28
v_fma_f32 v166, v166, s28, s28
v_fma_f32 v167, v167, s28, s28
v_rcp_f32 v160, v160
v_rcp_f32 v161, v161
v_rcp_f32 v162, v162
v_rcp_f32 v163, v163
v_rcp_f32 v164, v164
v_rcp_f32 v165, v165
s_setprio 0
v_add_u32 v245, 66560, v245
ds_read_b128 v[224:227], v245 offset:0
ds_read_b128 v[228:231], v245 offset:16896
ds_read_b128 v[232:235], v245 offset:32
ds_read_b128 v[236:239], v245 offset:16928
s_waitcnt lgkmcnt(3)
v_mfma_f32_32x32x16_bf16 v[144:159], v[224:227], v[4:7], 0
v_mfma_f32_32x32x16_bf16 v[128:143], v[224:227], v[0:3], 0
ds_read_b128 v[224:227], v245 offset:64
s_waitcnt lgkmcnt(3)
v_mfma_f32_32x32x16_bf16 v[208:223], v[228:231], v[4:7], 0
v_mfma_f32_32x32x16_bf16 v[192:207], v[228:231], v[0:3], 0
ds_read_b128 v[228:231], v245 offset:16960
s_waitcnt lgkmcnt(3)
v_mfma_f32_32x32x16_bf16 v[144:159], v[232:235], v[12:15], v[144:159]
ds_read_b32 v253, v248
v_mfma_f32_32x32x16_bf16 v[128:143], v[232:235], v[8:11], v[128:143]
ds_read_b128 v[232:235], v245 offset:96
s_waitcnt lgkmcnt(4)
v_mfma_f32_32x32x16_bf16 v[208:223], v[236:239], v[12:15], v[208:223]
v_mfma_f32_32x32x16_bf16 v[192:207], v[236:239], v[8:11], v[192:207]
ds_read_b128 v[236:239], v245 offset:16992
s_waitcnt lgkmcnt(4)
v_mfma_f32_32x32x16_bf16 v[144:159], v[224:227], v[20:23], v[144:159]
s_waitcnt lgkmcnt(2)
v_cmp_gt_u32 vcc, 25, v253
s_cbranch_vccnz L_waitQs25
L_goQs25:
v_mfma_f32_32x32x16_bf16 v[128:143], v[224:227], v[16:19], v[128:143]
ds_read_b128 v[224:227], v245 offset:128
v_mfma_f32_32x32x16_bf16 v[208:223], v[228:231], v[20:23], v[208:223]
s_add_u32 m0, s52, 0
s_add_u32 s31, s53, 65600
buffer_load_dwordx4 v250, s[16:19], s31 offen lds
v_mfma_f32_32x32x16_bf16 v[192:207], v[228:231], v[16:19], v[192:207]
ds_read_b128 v[228:231], v245 offset:17024
s_waitcnt lgkmcnt(3)
v_mfma_f32_32x32x16_bf16 v[144:159], v[232:235], v[28:31], v[144:159]
s_add_u32 m0, s52, 4096
s_add_u32 s31, s53, 73728
buffer_load_dwordx4 v250, s[16:19], s31 offen lds
v_mfma_f32_32x32x16_bf16 v[128:143], v[232:235], v[24:27], v[128:143]
ds_read_b128 v[232:235], v245 offset:160
s_waitcnt lgkmcnt(3)
v_mfma_f32_32x32x16_bf16 v[208:223], v[236:239], v[28:31], v[208:223]
s_add_u32 m0, s52, 8192
s_add_u32 s31, s53, 73792
buffer_load_dwordx4 v250, s[16:19], s31 offen lds
v_mfma_f32_32x32x16_bf16 v[192:207], v[236:239], v[24:27], v[192:207]
ds_read_b128 v[236:239], v245 offset:17056
s_waitcnt lgkmcnt(3)
v_mfma_f32_32x32x16_bf16 v[144:159], v[224:227], v[36:39], v[144:159]
s_add_u32 m0, s52, 12288
s_add_u32 s31, s53, 81920
buffer_load_dwordx4 v250, s[16:19], s31 offen lds
v_mfma_f32_32x32x16_bf16 v[128:143], v[224:227], v[32:35], v[128:143]
ds_read_b128 v[224:227], v245 offset:192
s_waitcnt lgkmcnt(3)
v_mfma_f32_32x32x16_bf16 v[208:223], v[228:231], v[36:39], v[208:223]
v_mfma_f32_32x32x16_bf16 v[192:207], v[228:231], v[32:35], v[192:207]
ds_read_b128 v[228:231], v245 offset:17088
s_waitcnt lgkmcnt(3)
v_mfma_f32_32x32x16_bf16 v[144:159], v[232:235], v[44:47], v[144:159]
s_add_u32 m0, s52, 16384
s_add_u32 s31, s53, 81984
buffer_load_dwordx4 v250, s[16:19], s31 offen lds
v_mfma_f32_32x32x16_bf16 v[128:143], v[232:235], v[40:43], v[128:143]
ds_read_b128 v[232:235], v245 offset:224
s_waitcnt lgkmcnt(3)
v_mfma_f32_32x32x16_bf16 v[208:223], v[236:239], v[44:47], v[208:223]
s_add_u32 m0, s52, 20480
s_add_u32 s31, s53, 90112
buffer_load_dwordx4 v250, s[16:19], s31 offen lds
v_mfma_f32_32x32x16_bf16 v[192:207], v[236:239], v[40:43], v[192:207]
ds_read_b128 v[236:239], v245 offset:17120
s_waitcnt lgkmcnt(3)
v_mfma_f32_32x32x16_bf16 v[144:159], v[224:227], v[52:55], v[144:159]
s_add_u32 m0, s52, 24576
s_add_u32 s31, s53, 90176
buffer_load_dwordx4 v250, s[16:19], s31 offen lds
v_mfma_f32_32x32x16_bf16 v[128:143], v[224:227], v[48:51], v[128:143]
ds_read_b128 v[224:227], v245 offset:256
s_waitcnt lgkmcnt(3)
v_mfma_f32_32x32x16_bf16 v[208:223], v[228:231], v[52:55], v[208:223]
s_add_u32 m0, s52, 28672
s_add_u32 s31, s53, 98304
buffer_load_dwordx4 v250, s[16:19], s31 offen lds
v_mfma_f32_32x32x16_bf16 v[192:207], v[228:231], v[48:51], v[192:207]
ds_read_b128 v[228:231], v245 offset:17152
s_waitcnt lgkmcnt(3)
v_mfma_f32_32x32x16_bf16 v[144:159], v[232:235], v[60:63], v[144:159]
v_mfma_f32_32x32x16_bf16 v[128:143], v[232:235], v[56:59], v[128:143]
ds_read_b128 v[232:235], v245 offset:288
s_waitcnt lgkmcnt(3)
v_mfma_f32_32x32x16_bf16 v[208:223], v[236:239], v[60:63], v[208:223]
s_add_u32 m0, s52, 32768
s_add_u32 s31, s53, 98368
buffer_load_dwordx4 v250, s[16:19], s31 offen lds
v_mfma_f32_32x32x16_bf16 v[192:207], v[236:239], v[56:59], v[192:207]
ds_read_b128 v[236:239], v245 offset:17184
s_waitcnt lgkmcnt(3)
v_mfma_f32_32x32x16_bf16 v[144:159], v[224:227], v[68:71], v[144:159]
s_add_u32 m0, s52, 36864
s_add_u32 s31, s53, 106496
buffer_load_dwordx4 v250, s[16:19], s31 offen lds
v_mfma_f32_32x32x16_bf16 v[128:143], v[224:227], v[64:67], v[128:143]
ds_read_b128 v[224:227], v245 offset:320
s_waitcnt lgkmcnt(3)
v_mfma_f32_32x32x16_bf16 v[208:223], v[228:231], v[68:71], v[208:223]
s_add_u32 m0, s52, 40960
s_add_u32 s31, s53, 106560
buffer_load_dwordx4 v250, s[16:19], s31 offen lds
v_mfma_f32_32x32x16_bf16 v[192:207], v[228:231], v[64:67], v[192:207]
ds_read_b128 v[228:231], v245 offset:17216
s_waitcnt lgkmcnt(3)
v_mfma_f32_32x32x16_bf16 v[144:159], v[232:235], v[76:79], v[144:159]
s_add_u32 m0, s52, 45056
s_add_u32 s31, s53, 114688
buffer_load_dwordx4 v250, s[16:19], s31 offen lds
v_mfma_f32_32x32x16_bf16 v[128:143], v[232:235], v[72:75], v[128:143]
ds_read_b128 v[232:235], v245 offset:352
s_waitcnt lgkmcnt(3)
v_mfma_f32_32x32x16_bf16 v[208:223], v[236:239], v[76:79], v[208:223]
v_mfma_f32_32x32x16_bf16 v[192:207], v[236:239], v[72:75], v[192:207]
ds_read_b128 v[236:239], v245 offset:17248
s_waitcnt lgkmcnt(3)
v_mfma_f32_32x32x16_bf16 v[144:159], v[224:227], v[84:87], v[144:159]
s_add_u32 m0, s52, 49152
s_add_u32 s31, s53, 114752
buffer_load_dwordx4 v250, s[16:19], s31 offen lds
v_mfma_f32_32x32x16_bf16 v[128:143], v[224:227], v[80:83], v[128:143]
ds_read_b128 v[224:227], v245 offset:384
s_waitcnt lgkmcnt(3)
v_mfma_f32_32x32x16_bf16 v[208:223], v[228:231], v[84:87], v[208:223]
s_add_u32 m0, s52, 53248
s_add_u32 s31, s53, 122880
buffer_load_dwordx4 v250, s[16:19], s31 offen lds
v_mfma_f32_32x32x16_bf16 v[192:207], v[228:231], v[80:83], v[192:207]
ds_read_b128 v[228:231], v245 offset:17280
s_waitcnt lgkmcnt(3)
v_mfma_f32_32x32x16_bf16 v[144:159], v[232:235], v[92:95], v[144:159]
s_add_u32 m0, s52, 57344
s_add_u32 s31, s53, 122944
buffer_load_dwordx4 v250, s[16:19], s31 offen lds
v_mfma_f32_32x32x16_bf16 v[128:143], v[232:235], v[88:91], v[128:143]
ds_read_b128 v[232:235], v245 offset:416
s_waitcnt lgkmcnt(3)
v_mfma_f32_32x32x16_bf16 v[208:223], v[236:239], v[92:95], v[208:223]
v_mfma_f32_32x32x16_bf16 v[192:207], v[236:239], v[88:91], v[192:207]
ds_read_b128 v[236:239], v245 offset:17312
s_waitcnt lgkmcnt(3)
v_mfma_f32_32x32x16_bf16 v[144:159], v[224:227], v[100:103], v[144:159]
v_mfma_f32_32x32x16_bf16 v[128:143], v[224:227], v[96:99], v[128:143]
ds_read_b128 v[224:227], v245 offset:448
s_waitcnt lgkmcnt(3)
v_mfma_f32_32x32x16_bf16 v[208:223], v[228:231], v[100:103], v[208:223]
v_mfma_f32_32x32x16_bf16 v[192:207], v[228:231], v[96:99], v[192:207]
ds_read_b128 v[228:231], v245 offset:17344
s_waitcnt lgkmcnt(3)
v_mfma_f32_32x32x16_bf16 v[144:159], v[232:235], v[108:111], v[144:159]
v_mfma_f32_32x32x16_bf16 v[128:143], v[232:235], v[104:107], v[128:143]
ds_read_b128 v[232:235], v245 offset:480
s_waitcnt lgkmcnt(3)
v_mfma_f32_32x32x16_bf16 v[208:223], v[236:239], v[108:111], v[208:223]
v_mfma_f32_32x32x16_bf16 v[192:207], v[236:239], v[104:107], v[192:207]
ds_read_b128 v[236:239], v245 offset:17376
s_waitcnt lgkmcnt(3)
v_mfma_f32_32x32x16_bf16 v[144:159], v[224:227], v[116:119], v[144:159]
v_mfma_f32_32x32x16_bf16 v[128:143], v[224:227], v[112:115], v[128:143]
s_waitcnt lgkmcnt(2)
v_mfma_f32_32x32x16_bf16 v[208:223], v[228:231], v[116:119], v[208:223]
v_mfma_f32_32x32x16_bf16 v[192:207], v[228:231], v[112:115], v[192:207]
s_waitcnt lgkmcnt(1)
v_mfma_f32_32x32x16_bf16 v[144:159], v[232:235], v[124:127], v[144:159]
v_mfma_f32_32x32x16_bf16 v[128:143], v[232:235], v[120:123], v[128:143]
s_waitcnt lgkmcnt(0)
v_mfma_f32_32x32x16_bf16 v[208:223], v[236:239], v[124:127], v[208:223]
v_mfma_f32_32x32x16_bf16 v[192:207], v[236:239], v[120:123], v[192:207]
s_waitcnt vmcnt(0)
v_mov_b32 v254, 30
ds_write_b32 v249, v254
v_rcp_f32 v166, v166
v_rcp_f32 v167, v167
v_mul_f32 v176, v176, v160
v_mul_f32 v177, v177, v161
v_mul_f32 v178, v178, v162
v_mul_f32 v179, v179, v163
v_mul_f32 v180, v180, v164
v_mul_f32 v181, v181, v165
v_mul_f32 v182, v182, v166
v_mul_f32 v183, v183, v167
v_cvt_pk_bf16_f32 v160, v176, v177
v_cvt_pk_bf16_f32 v161, v178, v179
v_cvt_pk_bf16_f32 v162, v180, v181
v_cvt_pk_bf16_f32 v163, v182, v183
ds_write_b128 v246, v[160:163] offset:50176
v_exp_f32 v168, v184
v_exp_f32 v169, v185
v_exp_f32 v170, v186
v_exp_f32 v171, v187
v_exp_f32 v172, v188
v_exp_f32 v173, v189
v_exp_f32 v174, v190
v_exp_f32 v175, v191
v_fma_f32 v168, v168, s28, s28
v_fma_f32 v169, v169, s28, s28
v_fma_f32 v170, v170, s28, s28
v_fma_f32 v171, v171, s28, s28
v_fma_f32 v172, v172, s28, s28
v_fma_f32 v173, v173, s28, s28
v_fma_f32 v174, v174, s28, s28
v_fma_f32 v175, v175, s28, s28
v_rcp_f32 v168, v168
v_rcp_f32 v169, v169
v_rcp_f32 v170, v170
v_rcp_f32 v171, v171
v_rcp_f32 v172, v172
v_rcp_f32 v173, v173
v_rcp_f32 v174, v174
v_rcp_f32 v175, v175
v_mul_f32 v184, v184, v168
v_mul_f32 v185, v185, v169
v_mul_f32 v186, v186, v170
v_mul_f32 v187, v187, v171
v_mul_f32 v188, v188, v172
v_mul_f32 v189, v189, v173
v_mul_f32 v190, v190, v174
v_mul_f32 v191, v191, v175
v_cvt_pk_bf16_f32 v168, v184, v185
v_cvt_pk_bf16_f32 v169, v186, v187
v_cvt_pk_bf16_f32 v170, v188, v189
v_cvt_pk_bf16_f32 v171, v190, v191
ds_write_b128 v247, v[168:171] offset:50176
v_mov_b32 v254, 35
ds_write_b32 v249, v254
s_nop 3
v_mul_f32 v144, s28, v144
v_mul_f32 v145, s28, v145
v_mul_f32 v146, s28, v146
v_mul_f32 v147, s28, v147
v_mul_f32 v148, s28, v148
v_mul_f32 v149, s28, v149
v_mul_f32 v150, s28, v150
v_mul_f32 v151, s28, v151
v_mul_f32 v152, s28, v152
v_mul_f32 v153, s28, v153
v_mul_f32 v154, s28, v154
v_mul_f32 v155, s28, v155
v_mul_f32 v156, s28, v156
v_mul_f32 v157, s28, v157
v_mul_f32 v158, s28, v158
v_mul_f32 v159, s28, v159
v_exp_f32 v144, v144
v_exp_f32 v145, v145
v_exp_f32 v146, v146
v_exp_f32 v147, v147
v_exp_f32 v148, v148
v_exp_f32 v149, v149
v_exp_f32 v150, v150
v_exp_f32 v151, v151
v_exp_f32 v152, v152
v_exp_f32 v153, v153
v_exp_f32 v154, v154
v_exp_f32 v155, v155
v_exp_f32 v156, v156
v_exp_f32 v157, v157
v_exp_f32 v158, v158
v_exp_f32 v159, v159
v_add_f32 v144, 1.0, v144
v_add_f32 v145, 1.0, v145
v_add_f32 v146, 1.0, v146
v_add_f32 v147, 1.0, v147
v_add_f32 v148, 1.0, v148
v_add_f32 v149, 1.0, v149
v_add_f32 v150, 1.0, v150
v_add_f32 v151, 1.0, v151
v_add_f32 v152, 1.0, v152
v_add_f32 v153, 1.0, v153
v_add_f32 v154, 1.0, v154
v_add_f32 v155, 1.0, v155
v_add_f32 v156, 1.0, v156
v_add_f32 v157, 1.0, v157
v_add_f32 v158, 1.0, v158
v_add_f32 v159, 1.0, v159
v_rcp_f32 v144, v144
v_rcp_f32 v145, v145
v_rcp_f32 v146, v146
v_rcp_f32 v147, v147
v_rcp_f32 v148, v148
v_rcp_f32 v149, v149
v_rcp_f32 v150, v150
v_rcp_f32 v151, v151
v_rcp_f32 v152, v152
v_rcp_f32 v153, v153
v_rcp_f32 v154, v154
v_rcp_f32 v155, v155
v_rcp_f32 v156, v156
v_rcp_f32 v157, v157
v_rcp_f32 v158, v158
v_rcp_f32 v159, v159
v_mul_f32 v128, v128, v144
v_mul_f32 v129, v129, v145
v_mul_f32 v130, v130, v146
v_mul_f32 v131, v131, v147
v_mul_f32 v132, v132, v148
v_mul_f32 v133, v133, v149
v_mul_f32 v134, v134, v150
v_mul_f32 v135, v135, v151
v_mul_f32 v136, v136, v152
v_mul_f32 v137, v137, v153
v_mul_f32 v138, v138, v154
v_mul_f32 v139, v139, v155
v_mul_f32 v140, v140, v156
v_mul_f32 v141, v141, v157
v_mul_f32 v251, v142, v158
v_mul_f32 v252, v143, v159
v_mul_f32 v144, v240, v244
v_mul_f32 v145, v240, v128
v_mul_f32 v146, v240, v129
v_mul_f32 v147, v240, v130
v_mul_f32 v148, v240, v131
v_mul_f32 v149, v240, v132
v_mul_f32 v150, v240, v133
v_mul_f32 v151, v240, v134
v_mul_f32 v152, v240, v135
v_mul_f32 v153, v240, v136
v_mul_f32 v154, v240, v137
v_mul_f32 v155, v240, v138
v_mul_f32 v156, v240, v139
v_mul_f32 v157, v240, v140
v_mul_f32 v158, v240, v141
v_mul_f32 v159, v240, v251
v_fmac_f32 v144, v242, v128
v_fmac_f32 v145, v242, v129
v_fmac_f32 v146, v242, v130
v_fmac_f32 v147, v242, v131
v_fmac_f32 v148, v242, v132
v_fmac_f32 v149, v242, v133
v_fmac_f32 v150, v242, v134
v_fmac_f32 v151, v242, v135
v_fmac_f32 v152, v242, v136
v_fmac_f32 v153, v242, v137
v_fmac_f32 v154, v242, v138
v_fmac_f32 v155, v242, v139
v_fmac_f32 v156, v242, v140
v_fmac_f32 v157, v242, v141
v_fmac_f32 v158, v242, v251
v_fmac_f32 v159, v242, v252
v_fmac_f32 v144, v241, v243
v_fmac_f32 v145, v241, v244
v_fmac_f32 v146, v241, v128
v_fmac_f32 v147, v241, v129
v_fmac_f32 v148, v241, v130
v_fmac_f32 v149, v241, v131
v_fmac_f32 v150, v241, v132
v_fmac_f32 v151, v241, v133
v_fmac_f32 v152, v241, v134
v_fmac_f32 v153, v241, v135
v_fmac_f32 v154, v241, v136
v_fmac_f32 v155, v241, v137
v_fmac_f32 v156, v241, v138
v_fmac_f32 v157, v241, v139
v_fmac_f32 v158, v241, v140
v_fmac_f32 v159, v241, v141
v_exp_f32 v128, v144
v_exp_f32 v129, v145
v_exp_f32 v130, v146
v_exp_f32 v131, v147
v_exp_f32 v132, v148
v_exp_f32 v133, v149
v_exp_f32 v134, v150
v_exp_f32 v135, v151
v_fma_f32 v128, v128, s28, s28
v_fma_f32 v129, v129, s28, s28
v_fma_f32 v130, v130, s28, s28
v_fma_f32 v131, v131, s28, s28
v_fma_f32 v132, v132, s28, s28
v_fma_f32 v133, v133, s28, s28
v_fma_f32 v134, v134, s28, s28
v_fma_f32 v135, v135, s28, s28
v_rcp_f32 v128, v128
v_rcp_f32 v129, v129
v_rcp_f32 v130, v130
v_rcp_f32 v131, v131
v_rcp_f32 v132, v132
v_rcp_f32 v133, v133
v_rcp_f32 v134, v134
v_rcp_f32 v135, v135
v_mul_f32 v144, v144, v128
v_mul_f32 v145, v145, v129
v_mul_f32 v146, v146, v130
v_mul_f32 v147, v147, v131
v_mul_f32 v148, v148, v132
v_mul_f32 v149, v149, v133
v_mul_f32 v150, v150, v134
v_mul_f32 v151, v151, v135
v_cvt_pk_bf16_f32 v128, v144, v145
v_cvt_pk_bf16_f32 v129, v146, v147
v_cvt_pk_bf16_f32 v130, v148, v149
v_cvt_pk_bf16_f32 v131, v150, v151
ds_write_b128 v246, v[128:131] offset:0
v_exp_f32 v136, v152
v_exp_f32 v137, v153
v_exp_f32 v138, v154
v_exp_f32 v139, v155
v_exp_f32 v140, v156
v_exp_f32 v141, v157
v_exp_f32 v142, v158
v_exp_f32 v143, v159
v_fma_f32 v136, v136, s28, s28
v_fma_f32 v137, v137, s28, s28
v_fma_f32 v138, v138, s28, s28
v_fma_f32 v139, v139, s28, s28
v_fma_f32 v140, v140, s28, s28
v_fma_f32 v141, v141, s28, s28
v_fma_f32 v142, v142, s28, s28
v_fma_f32 v143, v143, s28, s28
v_rcp_f32 v136, v136
v_rcp_f32 v137, v137
v_rcp_f32 v138, v138
v_rcp_f32 v139, v139
v_rcp_f32 v140, v140
v_rcp_f32 v141, v141
v_rcp_f32 v142, v142
v_rcp_f32 v143, v143
v_mul_f32 v152, v152, v136
v_mul_f32 v153, v153, v137
v_mul_f32 v154, v154, v138
v_mul_f32 v155, v155, v139
v_mul_f32 v156, v156, v140
v_mul_f32 v157, v157, v141
v_mul_f32 v158, v158, v142
v_mul_f32 v159, v159, v143
v_cvt_pk_bf16_f32 v136, v152, v153
v_cvt_pk_bf16_f32 v137, v154, v155
v_cvt_pk_bf16_f32 v138, v156, v157
v_cvt_pk_bf16_f32 v139, v158, v159
ds_write_b128 v247, v[136:139] offset:0
v_mov_b32 v254, 40
ds_write_b32 v249, v254
v_mul_f32 v208, s28, v208
v_mul_f32 v209, s28, v209
v_mul_f32 v210, s28, v210
v_mul_f32 v211, s28, v211
v_mul_f32 v212, s28, v212
v_mul_f32 v213, s28, v213
v_mul_f32 v214, s28, v214
v_mul_f32 v215, s28, v215
v_mul_f32 v216, s28, v216
v_mul_f32 v217, s28, v217
v_mul_f32 v218, s28, v218
v_mul_f32 v219, s28, v219
v_mul_f32 v220, s28, v220
v_mul_f32 v221, s28, v221
v_mul_f32 v222, s28, v222
v_mul_f32 v223, s28, v223
v_exp_f32 v208, v208
v_exp_f32 v209, v209
v_exp_f32 v210, v210
v_exp_f32 v211, v211
v_exp_f32 v212, v212
v_exp_f32 v213, v213
v_exp_f32 v214, v214
v_exp_f32 v215, v215
v_exp_f32 v216, v216
v_exp_f32 v217, v217
v_exp_f32 v218, v218
v_exp_f32 v219, v219
v_exp_f32 v220, v220
v_exp_f32 v221, v221
v_exp_f32 v222, v222
v_exp_f32 v223, v223
v_add_f32 v208, 1.0, v208
v_add_f32 v209, 1.0, v209
v_add_f32 v210, 1.0, v210
v_add_f32 v211, 1.0, v211
v_add_f32 v212, 1.0, v212
v_add_f32 v213, 1.0, v213
v_add_f32 v214, 1.0, v214
v_add_f32 v215, 1.0, v215
v_add_f32 v216, 1.0, v216
v_add_f32 v217, 1.0, v217
v_add_f32 v218, 1.0, v218
v_add_f32 v219, 1.0, v219
v_add_f32 v220, 1.0, v220
v_add_f32 v221, 1.0, v221
v_add_f32 v222, 1.0, v222
v_add_f32 v223, 1.0, v223
v_rcp_f32 v208, v208
v_rcp_f32 v209, v209
v_rcp_f32 v210, v210
v_rcp_f32 v211, v211
v_rcp_f32 v212, v212
v_rcp_f32 v213, v213
v_rcp_f32 v214, v214
v_rcp_f32 v215, v215
v_rcp_f32 v216, v216
v_rcp_f32 v217, v217
v_rcp_f32 v218, v218
v_rcp_f32 v219, v219
v_rcp_f32 v220, v220
v_rcp_f32 v221, v221
v_rcp_f32 v222, v222
v_rcp_f32 v223, v223
v_mul_f32 v192, v192, v208
v_mul_f32 v193, v193, v209
v_mul_f32 v194, v194, v210
v_mul_f32 v195, v195, v211
v_mul_f32 v196, v196, v212
v_mul_f32 v197, v197, v213
v_mul_f32 v198, v198, v214
v_mul_f32 v199, v199, v215
v_mul_f32 v200, v200, v216
v_mul_f32 v201, v201, v217
v_mul_f32 v202, v202, v218
v_mul_f32 v203, v203, v219
v_mul_f32 v204, v204, v220
v_mul_f32 v205, v205, v221
v_mul_f32 v243, v206, v222
v_mul_f32 v244, v207, v223
v_mul_f32 v208, v240, v252
v_mul_f32 v209, v240, v192
v_mul_f32 v210, v240, v193
v_mul_f32 v211, v240, v194
v_mul_f32 v212, v240, v195
v_mul_f32 v213, v240, v196
v_mul_f32 v214, v240, v197
v_mul_f32 v215, v240, v198
v_mul_f32 v216, v240, v199
v_mul_f32 v217, v240, v200
v_mul_f32 v218, v240, v201
v_mul_f32 v219, v240, v202
v_mul_f32 v220, v240, v203
v_mul_f32 v221, v240, v204
v_mul_f32 v222, v240, v205
v_mul_f32 v223, v240, v243
v_fmac_f32 v208, v242, v192
v_fmac_f32 v209, v242, v193
v_fmac_f32 v210, v242, v194
v_fmac_f32 v211, v242, v195
v_fmac_f32 v212, v242, v196
v_fmac_f32 v213, v242, v197
v_fmac_f32 v214, v242, v198
v_fmac_f32 v215, v242, v199
v_fmac_f32 v216, v242, v200
v_fmac_f32 v217, v242, v201
v_fmac_f32 v218, v242, v202
v_fmac_f32 v219, v242, v203
v_fmac_f32 v220, v242, v204
v_fmac_f32 v221, v242, v205
v_fmac_f32 v222, v242, v243
v_fmac_f32 v223, v242, v244
v_fmac_f32 v208, v241, v251
v_fmac_f32 v209, v241, v252
v_fmac_f32 v210, v241, v192
v_fmac_f32 v211, v241, v193
v_fmac_f32 v212, v241, v194
v_fmac_f32 v213, v241, v195
v_fmac_f32 v214, v241, v196
v_fmac_f32 v215, v241, v197
v_fmac_f32 v216, v241, v198
v_fmac_f32 v217, v241, v199
v_fmac_f32 v218, v241, v200
v_fmac_f32 v219, v241, v201
v_fmac_f32 v220, v241, v202
v_fmac_f32 v221, v241, v203
v_fmac_f32 v222, v241, v204
v_fmac_f32 v223, v241, v205
v_exp_f32 v192, v208
v_exp_f32 v193, v209
v_exp_f32 v194, v210
v_exp_f32 v195, v211
v_exp_f32 v196, v212
v_exp_f32 v197, v213
v_exp_f32 v198, v214
v_exp_f32 v199, v215
v_fma_f32 v192, v192, s28, s28
v_fma_f32 v193, v193, s28, s28
v_fma_f32 v194, v194, s28, s28
v_fma_f32 v195, v195, s28, s28
v_fma_f32 v196, v196, s28, s28
v_fma_f32 v197, v197, s28, s28
v_fma_f32 v198, v198, s28, s28
v_fma_f32 v199, v199, s28, s28
v_rcp_f32 v192, v192
v_rcp_f32 v193, v193
v_rcp_f32 v194, v194
v_rcp_f32 v195, v195
v_rcp_f32 v196, v196
v_rcp_f32 v197, v197
v_rcp_f32 v198, v198
v_rcp_f32 v199, v199
v_mul_f32 v208, v208, v192
v_mul_f32 v209, v209, v193
v_mul_f32 v210, v210, v194
v_mul_f32 v211, v211, v195
v_mul_f32 v212, v212, v196
v_mul_f32 v213, v213, v197
v_mul_f32 v214, v214, v198
v_mul_f32 v215, v215, v199
v_cvt_pk_bf16_f32 v192, v208, v209
v_cvt_pk_bf16_f32 v193, v210, v211
v_cvt_pk_bf16_f32 v194, v212, v213
v_cvt_pk_bf16_f32 v195, v214, v215
ds_write_b128 v246, v[192:195] offset:16896
v_exp_f32 v200, v216
v_exp_f32 v201, v217
v_exp_f32 v202, v218
v_exp_f32 v203, v219
v_exp_f32 v204, v220
v_exp_f32 v205, v221
v_exp_f32 v206, v222
v_exp_f32 v207, v223
v_fma_f32 v200, v200, s28, s28
v_fma_f32 v201, v201, s28, s28
v_fma_f32 v202, v202, s28, s28
v_fma_f32 v203, v203, s28, s28
v_fma_f32 v204, v204, s28, s28
v_fma_f32 v205, v205, s28, s28
v_fma_f32 v206, v206, s28, s28
v_fma_f32 v207, v207, s28, s28
v_rcp_f32 v200, v200
v_rcp_f32 v201, v201
v_rcp_f32 v202, v202
v_rcp_f32 v203, v203
v_rcp_f32 v204, v204
v_rcp_f32 v205, v205
v_rcp_f32 v206, v206
v_rcp_f32 v207, v207
v_mul_f32 v216, v216, v200
v_mul_f32 v217, v217, v201
v_mul_f32 v218, v218, v202
v_mul_f32 v219, v219, v203
v_mul_f32 v220, v220, v204
v_mul_f32 v221, v221, v205
v_mul_f32 v222, v222, v206
v_mul_f32 v223, v223, v207
v_cvt_pk_bf16_f32 v200, v216, v217
v_cvt_pk_bf16_f32 v201, v218, v219
v_cvt_pk_bf16_f32 v202, v220, v221
v_cvt_pk_bf16_f32 v203, v222, v223
ds_write_b128 v247, v[200:203] offset:16896
v_mov_b32 v254, 50
ds_write_b32 v249, v254
s_endpgm
L_waitQs20:
ds_read_b32 v253, v248
s_waitcnt lgkmcnt(0)
v_cmp_gt_u32 vcc, 20, v253
s_cbranch_vccnz L_waitQs20
s_branch L_goQs20
L_waitQs25:
ds_read_b32 v253, v248
s_waitcnt lgkmcnt(0)
v_cmp_gt_u32 vcc, 25, v253
s_cbranch_vccnz L_waitQs25
s_branch L_goQs25
L_end:
s_endpgm
.section .rodata,"a"
.p2align 6
.amdhsa_kernel standalone__conformer_conv_module__speech_kernel
  .amdhsa_next_free_vgpr 256
  .amdhsa_next_free_sgpr 102
  .amdhsa_accum_offset 256
  .amdhsa_group_segment_fixed_size 0
  .amdhsa_kernarg_size 56
  .amdhsa_user_sgpr_count 2
  .amdhsa_user_sgpr_kernarg_segment_ptr 1
  .amdhsa_system_sgpr_workgroup_id_x 1
.end_amdhsa_kernel
```
